```python
import torch

def _softmax(x, axis=-1):
    return torch.softmax(x, dim=axis)
def _gelu(x):
    return torch.nn.functional.gelu(x, approximate="tanh")
def _silu(x):
    return torch.nn.functional.silu(x)
def _sigmoid(x):
    return torch.sigmoid(x)
def _layernorm(x, axis=-1, eps=1e-5):
    m = x.mean(dim=axis, keepdim=True)
    v = x.var(dim=axis, keepdim=True, unbiased=False)
    return (x - m) / torch.sqrt(v + eps)
def _scatter_add(tgt, idx, src, axis=0):
    return tgt.clone().index_add_(axis, idx, src)
def _segment_sum(src, seg, n):
    out = torch.zeros((n,) + src.shape[1:], dtype=src.dtype)
    return out.index_add_(0, seg, src)
def _pad(x, pw):
    flat = tuple(v for pair in reversed(pw) for v in pair)
    return torch.nn.functional.pad(x, flat)

kernel_name = 'standalone__dense_activation_squared_relu__prompt'

def setup_inputs():

    _w = (lambda a: (lambda t: t.to(torch.bfloat16) if t.is_floating_point() else t)(torch.as_tensor(a)))
    B, S, D, F = 1, 2048, 512, 1792
    return {
        "x": _w((lambda *s: torch.randn(*s, dtype=torch.bfloat16) * 0.05)(B, S, D)),
        "w1": _w((lambda *s: torch.randn(*s, dtype=torch.bfloat16) * 0.05)(D, F)),
        "b1": _w((lambda *s: torch.randn(*s, dtype=torch.bfloat16) * 0.05)(F)),
        "w2": _w((lambda *s: torch.randn(*s, dtype=torch.bfloat16) * 0.05)(F, D)),
        "b2": _w((lambda *s: torch.randn(*s, dtype=torch.bfloat16) * 0.05)(D)),
    }

def reference(x, w1, b1, w2, b2):
    h = torch.einsum("bsd,df->bsf", x, w1) + b1
    zero = torch.zeros_like(h)
    r = torch.where(h > zero, h, zero)
    h = r * r
    out = torch.einsum("bsf,fd->bsd", h, w2) + b2
    return out
```

```asm
; @launch grid=(256,1,1) block=(256,1,1) lds=163840
.amdgcn_target "amdgcn-amd-amdhsa--gfx950"
.text
.globl standalone__dense_activation_squared_relu__prompt_kernel
.p2align 8
.type standalone__dense_activation_squared_relu__prompt_kernel,@function
standalone__dense_activation_squared_relu__prompt_kernel:
    s_load_dwordx16 s[4:19], s[0:1], 0
    s_cmp_ge_u32 s2, 256
    s_cbranch_scc1 L_end_standalone__dense_activation_squared_relu__prompt_kernel
    v_lshrrev_b32 v15, 6, v0
    v_and_b32 v0, 63, v0
    v_readfirstlane_b32 s3, v15
    s_and_b32 s79, s2, 7
    s_lshr_b32 s78, s2, 3
    s_lshr_b32 s86, s79, 1
    s_and_b32 s87, s78, 3
    s_lshl2_add_u32 s80, s86, s87
    s_and_b32 s85, s79, 1
    s_mul_i32 s81, s85, 7
    s_lshr_b32 s99, s78, 2
    s_add_u32 s81, s81, s99
    v_lshrrev_b32 v62, 4, v0
    s_mov_b32 s98, s79
    s_lshl_b32 s99, s81, 8
    s_lshl_b32 s100, s80, 17
    s_lshl_b32 s85, s3, 4
    v_add_u32 v15, s85, v62
    v_mul_u32_u24 v15, 3584, v15
    v_lshlrev_b32 v63, 2, v62
    v_xor_b32 v63, v63, v0
    v_and_b32 v63, 15, v63
    v_lshl_add_u32 v2, v63, 4, v15
    v_add_u32 v3, 13312, v2
    v_xor_b32 v5, 32, v2
    v_add_u32 v4, 26624, v5
    v_add_u32 v5, 39936, v5
    s_lshl_b32 s88, s3, 12
    s_mov_b32 s26, 1835008
    s_mov_b32 s27, 0x20000
    s_and_b32 s69, s98, 7
    s_mul_i32 s52, s69, 229376
    s_add_u32 s52, s52, s99
    s_lshl_b32 s60, s69, 7
    s_add_u32 s60, s60, s100
    v_lshrrev_b32 v15, 3, v0
    v_add_u32 v15, s85, v15
    v_lshlrev_b32 v15, 10, v15
    v_xor_b32 v63, v62, v0
    v_and_b32 v63, 7, v63
    v_lshl_add_u32 v6, v63, 4, v15
    v_xor_b32 v7, 64, v6
    v_add_u32 v7, 7168, v7
    s_lshl_b32 s89, s3, 11
    s_mov_b32 s22, 2097152
    s_mov_b32 s23, 0x20000
    s_mov_b32 s101, s2
    s_mov_b32 m0, s88
    s_cmp_ge_u32 s78, 28
    s_waitcnt lgkmcnt(0)
    s_mov_b64 s[24:25], s[6:7]
    s_mov_b64 s[20:21], s[4:5]
    s_cbranch_scc1 L_spare0
    buffer_load_dwordx4 v2, s[24:27], s52 offen offset:0 lds
    buffer_load_dwordx4 v3, s[24:27], s52 offen offset:1024 lds
    buffer_load_dwordx4 v4, s[24:27], s52 offen offset:2048 lds
    buffer_load_dwordx4 v5, s[24:27], s52 offen offset:3072 lds
    s_add_u32 m0, s89, 16384
    s_nop 0
    buffer_load_dwordx4 v6, s[20:23], s60 offen offset:0 lds
    buffer_load_dwordx4 v7, s[20:23], s60 offen offset:1024 lds
    s_lshl_b32 s85, s3, 6
    s_add_u32 s85, s85, s99
    s_load_dwordx16 s[36:51], s[8:9], s85
    s_add_u32 s69, s98, 1
    s_and_b32 s69, s69, 7
    s_mul_i32 s53, s69, 229376
    s_add_u32 s53, s53, s99
    s_lshl_b32 s61, s69, 7
    s_add_u32 s61, s61, s100
    s_and_b32 s76, s78, 3
    s_lshl2_add_u32 s76, s76, s3
    s_lshl_b32 s76, s76, 2
    v_bfe_u32 v44, v0, 1, 2
    v_add_u32 v44, s76, v44
    v_mul_u32_u24 v44, 3584, v44
    v_and_b32 v45, 1, v0
    v_lshl_or_b32 v44, v45, 7, v44
    s_mov_b64 exec, 0xff
    buffer_load_dword v49, v44, s[24:27], s53 offen
    s_mov_b64 exec, -1
    s_add_u32 m0, s88, 24576
    s_nop 0
    buffer_load_dwordx4 v2, s[24:27], s53 offen offset:0 lds
    s_add_u32 s69, s98, 2
    s_and_b32 s69, s69, 7
    s_mul_i32 s54, s69, 229376
    s_add_u32 s54, s54, s99
    buffer_load_dwordx4 v3, s[24:27], s53 offen offset:1024 lds
    s_lshl_b32 s62, s69, 7
    s_add_u32 s62, s62, s100
    v_bfe_u32 v63, v0, 2, 2
    v_lshl_add_u32 v15, v62, 3, v63
    buffer_load_dwordx4 v4, s[24:27], s53 offen offset:2048 lds
    v_lshlrev_b32 v15, 8, v15
    v_xor_b32 v63, s3, v63
    v_lshl_or_b32 v15, v63, 6, v15
    v_bfe_u32 v63, v0, 4, 1
    buffer_load_dwordx4 v5, s[24:27], s53 offen offset:3072 lds
    s_add_u32 m0, s89, 40960
    v_lshl_or_b32 v15, v63, 5, v15
    v_and_b32 v63, 3, v0
    v_lshl_or_b32 v8, v63, 3, v15
    v_xor_b32 v9, 32, v8
    buffer_load_dwordx4 v6, s[20:23], s61 offen offset:0 lds
    v_and_b32 v15, 15, v0
    v_lshlrev_b32 v15, 7, v15
    v_bfe_u32 v63, v0, 1, 3
    v_xor_b32 v63, v63, v62
    buffer_load_dwordx4 v7, s[20:23], s61 offen offset:1024 lds
    s_add_u32 m0, s88, 49152
    v_lshl_or_b32 v10, v63, 4, v15
    v_xor_b32 v11, 64, v10
    s_add_u32 s69, s98, 3
    s_and_b32 s69, s69, 7
    buffer_load_dwordx4 v2, s[24:27], s54 offen offset:0 lds
    s_mul_i32 s55, s69, 229376
    s_add_u32 s55, s55, s99
    s_lshl_b32 s63, s69, 7
    s_add_u32 s63, s63, s100
    buffer_load_dwordx4 v3, s[24:27], s54 offen offset:1024 lds
    s_add_u32 s69, s98, 4
    s_and_b32 s69, s69, 7
    s_mul_i32 s56, s69, 229376
    s_add_u32 s56, s56, s99
    buffer_load_dwordx4 v4, s[24:27], s54 offen offset:2048 lds
    s_lshl_b32 s64, s69, 7
    s_add_u32 s64, s64, s100
    buffer_load_dwordx4 v5, s[24:27], s54 offen offset:3072 lds
    s_add_u32 m0, s89, 65536
    s_nop 0
    buffer_load_dwordx4 v6, s[20:23], s62 offen offset:0 lds
    buffer_load_dwordx4 v7, s[20:23], s62 offen offset:1024 lds
    s_add_u32 m0, s88, 73728
    s_waitcnt lgkmcnt(0)
    v_mov_b32 v32, s36
    v_mov_b32 v33, s37
    v_mov_b32 v34, s44
    v_mov_b32 v35, s45
    s_mov_b32 exec_lo, 0xffff0000
    v_mov_b32 v32, s38
    v_mov_b32 v33, s39
    v_mov_b32 v34, s46
    v_mov_b32 v35, s47
    s_mov_b32 exec_lo, 0
    v_mov_b32 v32, s40
    v_mov_b32 v33, s41
    v_mov_b32 v34, s48
    v_mov_b32 v35, s49
    s_mov_b32 exec_hi, 0xffff0000
    v_mov_b32 v32, s42
    v_mov_b32 v33, s43
    v_mov_b32 v34, s50
    v_mov_b32 v35, s51
    s_mov_b64 exec, -1
    s_add_u32 s69, s98, 5
    s_and_b32 s69, s69, 7
    s_mul_i32 s57, s69, 229376
    s_add_u32 s57, s57, s99
    s_lshl_b32 s65, s69, 7
    s_add_u32 s65, s65, s100
    s_add_u32 s69, s98, 6
    s_and_b32 s69, s69, 7
    v_lshlrev_b32 v16, 16, v32
    v_and_b32 v17, 0xffff0000, v32
    v_lshlrev_b32 v18, 16, v33
    v_and_b32 v19, 0xffff0000, v33
    v_lshlrev_b32 v20, 16, v34
    v_and_b32 v21, 0xffff0000, v34
    v_lshlrev_b32 v22, 16, v35
    v_and_b32 v23, 0xffff0000, v35
    s_waitcnt vmcnt(13)
    s_barrier
    ds_read_b64_tr_b16 v[128:129], v8 offset:0
    ds_read_b128 a[224:227], v10 offset:16384
    ds_read_b64_tr_b16 v[130:131], v8 offset:1024
    ds_read_b128 a[228:231], v10 offset:18432
    ds_read_b64_tr_b16 v[132:133], v9 offset:0
    ds_read_b128 a[232:235], v10 offset:20480
    ds_read_b64_tr_b16 v[134:135], v9 offset:1024
    ds_read_b128 a[236:239], v10 offset:22528
    s_waitcnt lgkmcnt(0)
    v_mfma_f32_16x16x32_bf16 v[64:67], v[128:131], a[224:227], v[16:19]
    ds_read_b64_tr_b16 v[136:137], v8 offset:8192
    ds_read_b128 a[240:243], v11 offset:16384
    buffer_load_dwordx4 v2, s[24:27], s55 offen offset:0 lds
    v_mfma_f32_16x16x32_bf16 v[68:71], v[132:135], a[224:227], v[20:23]
    ds_read_b64_tr_b16 v[138:139], v8 offset:9216
    ds_read_b128 a[244:247], v11 offset:18432
    v_mfma_f32_16x16x32_bf16 v[72:75], v[128:131], a[228:231], v[16:19]
    ds_read_b64_tr_b16 v[140:141], v9 offset:8192
    ds_read_b128 a[248:251], v11 offset:20480
    v_mfma_f32_16x16x32_bf16 v[76:79], v[132:135], a[228:231], v[20:23]
    ds_read_b64_tr_b16 v[142:143], v9 offset:9216
    ds_read_b128 a[252:255], v11 offset:22528
    buffer_load_dwordx4 v3, s[24:27], s55 offen offset:1024 lds
    v_mfma_f32_16x16x32_bf16 v[80:83], v[128:131], a[232:235], v[16:19]
    s_mul_i32 s58, s69, 229376
    s_add_u32 s58, s58, s99
    s_lshl_b32 s66, s69, 7
    s_add_u32 s66, s66, s100
    v_mfma_f32_16x16x32_bf16 v[84:87], v[132:135], a[232:235], v[20:23]
    s_add_u32 s69, s98, 7
    s_and_b32 s69, s69, 7
    s_mul_i32 s59, s69, 229376
    s_add_u32 s59, s59, s99
    v_mfma_f32_16x16x32_bf16 v[88:91], v[128:131], a[236:239], v[16:19]
    buffer_load_dwordx4 v4, s[24:27], s55 offen offset:2048 lds
    s_lshl_b32 s67, s69, 7
    s_add_u32 s67, s67, s100
    v_add_u32 v46, 65536, v6
    v_add_u32 v47, 65536, v7
    v_mfma_f32_16x16x32_bf16 v[92:95], v[132:135], a[236:239], v[20:23]
    s_mov_b64 s[28:29], s[10:11]
    s_mov_b32 s30, 1835008
    s_mov_b32 s31, 0x20000
    s_mov_b64 s[32:33], s[18:19]
    s_waitcnt lgkmcnt(0)
    v_mfma_f32_16x16x32_bf16 v[64:67], v[136:139], a[240:243], v[64:67]
    s_waitcnt vmcnt(9)
    s_barrier
    ds_read_b64_tr_b16 v[144:145], v8 offset:24576
    ds_read_b128 a[224:227], v10 offset:40960
    buffer_load_dwordx4 v5, s[24:27], s55 offen offset:3072 lds
    s_add_u32 m0, s89, 90112
    v_mfma_f32_16x16x32_bf16 v[68:71], v[140:143], a[240:243], v[68:71]
    ds_read_b64_tr_b16 v[146:147], v8 offset:25600
    ds_read_b128 a[228:231], v10 offset:43008
    v_mfma_f32_16x16x32_bf16 v[72:75], v[136:139], a[244:247], v[72:75]
    ds_read_b64_tr_b16 v[148:149], v9 offset:24576
    ds_read_b128 a[232:235], v10 offset:45056
    v_mfma_f32_16x16x32_bf16 v[76:79], v[140:143], a[244:247], v[76:79]
    ds_read_b64_tr_b16 v[150:151], v9 offset:25600
    ds_read_b128 a[236:239], v10 offset:47104
    buffer_load_dwordx4 v6, s[20:23], s63 offen offset:0 lds
    v_mfma_f32_16x16x32_bf16 v[80:83], v[136:139], a[248:251], v[80:83]
    s_mov_b32 s34, 8404992
    s_mov_b32 s35, 0x20000
    s_mov_b64 s[48:49], s[12:13]
    s_mov_b32 s50, 1024
    v_mfma_f32_16x16x32_bf16 v[84:87], v[140:143], a[248:251], v[84:87]
    s_mov_b32 s51, 0x20000
    s_mov_b64 s[36:37], s[14:15]
    s_mov_b32 s38, 2097152
    s_mov_b32 s39, 0x20000
    v_mfma_f32_16x16x32_bf16 v[88:91], v[136:139], a[252:255], v[88:91]
    buffer_load_dwordx4 v7, s[20:23], s63 offen offset:1024 lds
    s_add_u32 m0, s88, 98304
    s_mov_b64 s[40:41], s[16:17]
    s_mov_b32 s42, 64
    s_mov_b32 s43, 0x20000
    s_and_b32 s85, s78, 28
    v_mfma_f32_16x16x32_bf16 v[92:95], v[140:143], a[252:255], v[92:95]
    s_lshr_b32 s84, 929382928, s85
    s_and_b32 s84, s84, 7
    s_and_b32 s83, s78, 1
    s_bfe_u32 s82, s78, 0x10001
    s_waitcnt lgkmcnt(0)
    v_mfma_f32_16x16x32_bf16 v[64:67], v[144:147], a[224:227], v[64:67]
    ds_read_b64_tr_b16 v[152:153], v8 offset:32768
    ds_read_b128 a[240:243], v11 offset:40960
    buffer_load_dwordx4 v2, s[24:27], s56 offen offset:0 lds
    v_mfma_f32_16x16x32_bf16 v[68:71], v[148:151], a[224:227], v[68:71]
    ds_read_b64_tr_b16 v[154:155], v8 offset:33792
    ds_read_b128 a[244:247], v11 offset:43008
    v_mfma_f32_16x16x32_bf16 v[72:75], v[144:147], a[228:231], v[72:75]
    ds_read_b64_tr_b16 v[156:157], v9 offset:32768
    ds_read_b128 a[248:251], v11 offset:45056
    v_mfma_f32_16x16x32_bf16 v[76:79], v[148:151], a[228:231], v[76:79]
    ds_read_b64_tr_b16 v[158:159], v9 offset:33792
    ds_read_b128 a[252:255], v11 offset:47104
    buffer_load_dwordx4 v3, s[24:27], s56 offen offset:1024 lds
    v_mfma_f32_16x16x32_bf16 v[80:83], v[144:147], a[232:235], v[80:83]
    s_lshl1_add_u32 s82, s79, s82
    s_xor_b32 s91, s83, s84
    v_lshlrev_b32 v1, 4, v0
    s_lshl2_add_u32 s86, s81, s3
    v_mfma_f32_16x16x32_bf16 v[84:87], v[148:151], a[232:235], v[84:87]
    s_mul_i32 s92, s80, 458752
    s_lshl_b32 s85, s86, 10
    s_add_u32 s92, s92, s85
    s_mul_i32 s85, s86, 0x124a
    v_mfma_f32_16x16x32_bf16 v[88:91], v[144:147], a[236:239], v[88:91]
    buffer_load_dwordx4 v4, s[24:27], s56 offen offset:2048 lds
    s_lshr_b32 s85, s85, 16
    s_mul_i32 s87, s85, 14
    s_sub_u32 s86, s86, s87
    s_lshl3_add_u32 s85, s80, s85
    v_mfma_f32_16x16x32_bf16 v[92:95], v[148:151], a[236:239], v[92:95]
    s_lshl_b32 s85, s85, 7
    s_add_u32 s85, s85, 8388608
    s_lshl2_add_u32 s85, s86, s85
    v_mov_b32 v50, 0x7ff00000
    s_waitcnt lgkmcnt(0)
    v_mfma_f32_16x16x32_bf16 v[64:67], v[152:155], a[240:243], v[64:67]
    s_waitcnt vmcnt(9)
    s_barrier
    v_add_u32 v8, 49152, v8
    v_add_u32 v9, 49152, v9
    v_add_u32 v10, 49152, v10
    v_add_u32 v11, 49152, v11
    ds_read_b64_tr_b16 v[160:161], v8 offset:0
    ds_read_b128 a[224:227], v10 offset:16384
    buffer_load_dwordx4 v5, s[24:27], s56 offen offset:3072 lds
    s_add_u32 m0, s89, 114688
    v_mfma_f32_16x16x32_bf16 v[68:71], v[156:159], a[240:243], v[68:71]
    ds_read_b64_tr_b16 v[162:163], v8 offset:1024
    ds_read_b128 a[228:231], v10 offset:18432
    v_mfma_f32_16x16x32_bf16 v[72:75], v[152:155], a[244:247], v[72:75]
    ds_read_b64_tr_b16 v[164:165], v9 offset:0
    ds_read_b128 a[232:235], v10 offset:20480
    v_mfma_f32_16x16x32_bf16 v[76:79], v[156:159], a[244:247], v[76:79]
    ds_read_b64_tr_b16 v[166:167], v9 offset:1024
    ds_read_b128 a[236:239], v10 offset:22528
    buffer_load_dwordx4 v6, s[20:23], s64 offen offset:0 lds
    v_mfma_f32_16x16x32_bf16 v[80:83], v[152:155], a[248:251], v[80:83]
    v_writelane_b32 v50, s85, 0
    s_lshl2_add_u32 s85, s82, s83
    s_mul_i32 s93, s85, 114688
    s_mul_i32 s86, s3, 14336
    v_mfma_f32_16x16x32_bf16 v[84:87], v[156:159], a[248:251], v[84:87]
    s_add_u32 s93, s93, s86
    s_lshl3_add_u32 s85, s85, s3
    s_lshl_b32 s68, s85, 12
    s_lshl_b32 s87, s84, 7
    v_mfma_f32_16x16x32_bf16 v[88:91], v[152:155], a[252:255], v[88:91]
    buffer_load_dwordx4 v7, s[20:23], s64 offen offset:1024 lds
    s_add_u32 m0, s88, 122880
    s_add_u32 s68, s68, s87
    v_lshrrev_b32 v15, 3, v0
    v_lshlrev_b32 v15, 10, v15
    v_lshlrev_b32 v63, 1, v62
    v_mfma_f32_16x16x32_bf16 v[92:95], v[156:159], a[252:255], v[92:95]
    v_xor_b32 v63, v63, v0
    v_and_b32 v63, 7, v63
    v_lshl_add_u32 v36, v63, 4, v15
    v_add_u32 v37, 7168, v36
    s_waitcnt lgkmcnt(0)
    v_mfma_f32_16x16x32_bf16 v[64:67], v[160:163], a[224:227], v[64:67]
    ds_read_b64_tr_b16 v[168:169], v8 offset:8192
    ds_read_b128 a[240:243], v11 offset:16384
    buffer_load_dwordx4 v2, s[24:27], s57 offen offset:0 lds
    v_mfma_f32_16x16x32_bf16 v[68:71], v[164:167], a[224:227], v[68:71]
    ds_read_b64_tr_b16 v[170:171], v8 offset:9216
    ds_read_b128 a[244:247], v11 offset:18432
    v_mfma_f32_16x16x32_bf16 v[72:75], v[160:163], a[228:231], v[72:75]
    ds_read_b64_tr_b16 v[172:173], v9 offset:8192
    ds_read_b128 a[248:251], v11 offset:20480
    v_mfma_f32_16x16x32_bf16 v[76:79], v[164:167], a[228:231], v[76:79]
    ds_read_b64_tr_b16 v[174:175], v9 offset:9216
    ds_read_b128 a[252:255], v11 offset:22528
    buffer_load_dwordx4 v3, s[24:27], s57 offen offset:1024 lds
    v_mfma_f32_16x16x32_bf16 v[80:83], v[160:163], a[232:235], v[80:83]
    v_add_u32 v38, 14336, v36
    v_add_u32 v39, 21504, v36
    s_mul_i32 s94, s3, 458752
    s_add_u32 s94, s94, s87
    v_mfma_f32_16x16x32_bf16 v[84:87], v[164:167], a[232:235], v[84:87]
    s_and_b32 s85, s91, 1
    s_mul_i32 s86, s85, 229376
    s_add_u32 s94, s94, s86
    s_lshl_b32 s86, s86, 1
    v_mfma_f32_16x16x32_bf16 v[88:91], v[160:163], a[236:239], v[88:91]
    buffer_load_dwordx4 v4, s[24:27], s57 offen offset:2048 lds
    s_sub_u32 s95, 32768, s86
    s_mul_i32 s86, s85, 7168
    s_add_u32 s93, s93, s86
    s_lshl_b32 s86, s86, 1
    v_mfma_f32_16x16x32_bf16 v[92:95], v[164:167], a[236:239], v[92:95]
    s_sub_u32 s96, 3072, s86
    s_add_u32 s97, s86, 46080
    s_add_u32 s90, s86, 160768
    v_and_b32 v63, 15, v0
    s_waitcnt lgkmcnt(0)
    v_mfma_f32_16x16x32_bf16 v[64:67], v[168:171], a[240:243], v[64:67]
    s_waitcnt vmcnt(9)
    s_barrier
    ds_read_b64_tr_b16 v[176:177], v8 offset:24576
    ds_read_b128 a[224:227], v10 offset:40960
    buffer_load_dwordx4 v5, s[24:27], s57 offen offset:3072 lds
    s_add_u32 m0, s89, 139264
    v_mfma_f32_16x16x32_bf16 v[68:71], v[172:175], a[240:243], v[68:71]
    ds_read_b64_tr_b16 v[178:179], v8 offset:25600
    ds_read_b128 a[228:231], v10 offset:43008
    v_mfma_f32_16x16x32_bf16 v[72:75], v[168:171], a[244:247], v[72:75]
    ds_read_b64_tr_b16 v[180:181], v9 offset:24576
    ds_read_b128 a[232:235], v10 offset:45056
    v_mfma_f32_16x16x32_bf16 v[76:79], v[172:175], a[244:247], v[76:79]
    ds_read_b64_tr_b16 v[182:183], v9 offset:25600
    ds_read_b128 a[236:239], v10 offset:47104
    buffer_load_dwordx4 v6, s[20:23], s65 offen offset:0 lds
    v_mfma_f32_16x16x32_bf16 v[80:83], v[168:171], a[248:251], v[80:83]
    v_lshlrev_b32 v60, 3, v63
    v_lshl_or_b32 v60, v62, 10, v60
    s_lshl_b32 s86, s3, 2
    v_add_u32 v15, s86, v62
    v_mfma_f32_16x16x32_bf16 v[84:87], v[172:175], a[248:251], v[84:87]
    v_xor_b32 v15, v15, v63
    v_lshlrev_b32 v15, 4, v15
    v_lshl_or_b32 v59, v63, 8, v15
    v_add_u32 v59, 98304, v59
    v_mfma_f32_16x16x32_bf16 v[88:91], v[168:171], a[252:255], v[88:91]
    buffer_load_dwordx4 v7, s[20:23], s65 offen offset:1024 lds
    s_add_u32 m0, s88, 0
    v_xor_b32 v15, v63, v62
    v_lshlrev_b32 v15, 4, v15
    v_lshl_or_b32 v15, v62, 8, v15
    s_add_u32 s86, s88, 98304
    v_mfma_f32_16x16x32_bf16 v[92:95], v[172:175], a[252:255], v[92:95]
    v_add_u32 v55, s86, v15
    v_xor_b32 v56, 64, v55
    v_xor_b32 v57, 128, v55
    v_xor_b32 v58, 192, v55
    s_waitcnt lgkmcnt(0)
    v_mfma_f32_16x16x32_bf16 v[64:67], v[176:179], a[224:227], v[64:67]
    ds_read_b64_tr_b16 v[184:185], v8 offset:32768
    ds_read_b128 a[240:243], v11 offset:40960
    buffer_load_dwordx4 v2, s[24:27], s58 offen offset:0 lds
    v_mfma_f32_16x16x32_bf16 v[68:71], v[180:183], a[224:227], v[68:71]
    ds_read_b64_tr_b16 v[186:187], v8 offset:33792
    ds_read_b128 a[244:247], v11 offset:43008
    v_mfma_f32_16x16x32_bf16 v[72:75], v[176:179], a[228:231], v[72:75]
    ds_read_b64_tr_b16 v[188:189], v9 offset:32768
    ds_read_b128 a[248:251], v11 offset:45056
    v_mfma_f32_16x16x32_bf16 v[76:79], v[180:183], a[228:231], v[76:79]
    ds_read_b64_tr_b16 v[190:191], v9 offset:33792
    ds_read_b128 a[252:255], v11 offset:47104
    buffer_load_dwordx4 v3, s[24:27], s58 offen offset:1024 lds
    v_mfma_f32_16x16x32_bf16 v[80:83], v[176:179], a[232:235], v[80:83]
    v_bfe_u32 v63, v0, 2, 2
    v_lshl_add_u32 v15, v62, 2, v63
    v_lshlrev_b32 v15, 7, v15
    v_bfe_u32 v63, v0, 3, 2
    v_mfma_f32_16x16x32_bf16 v[84:87], v[180:183], a[232:235], v[84:87]
    v_lshl_or_b32 v15, v63, 5, v15
    v_and_b32 v63, 3, v0
    v_lshl_or_b32 v48, v63, 3, v15
    s_lshl3_add_u32 s85, s82, s3
    v_mfma_f32_16x16x32_bf16 v[88:91], v[176:179], a[236:239], v[88:91]
    buffer_load_dwordx4 v4, s[24:27], s58 offen offset:2048 lds
    s_lshl_b32 s85, s85, 7
    s_add_u32 s85, s85, 8388608
    s_add_u32 s0, s32, s85
    s_addc_u32 s1, s33, 0
    v_mfma_f32_16x16x32_bf16 v[92:95], v[180:183], a[236:239], v[92:95]
    v_lshlrev_b32 v54, 2, v0
    v_add_u32 v51, s85, v54
    v_mov_b32 v61, 1
    v_mov_b32 v15, 0x7ff00000
    s_waitcnt lgkmcnt(0)
    v_mfma_f32_16x16x32_bf16 v[64:67], v[184:187], a[240:243], v[64:67]
    s_waitcnt vmcnt(9)
    s_barrier
    v_add_u32 v8, 49152, v8
    v_add_u32 v9, 49152, v9
    v_add_u32 v10, 49152, v10
    v_add_u32 v11, 49152, v11
    ds_read_b64_tr_b16 v[192:193], v8 offset:0
    ds_read_b128 a[224:227], v10 offset:16384
    buffer_load_dwordx4 v5, s[24:27], s58 offen offset:3072 lds
    s_add_u32 m0, s89, 16384
    v_mfma_f32_16x16x32_bf16 v[68:71], v[188:191], a[240:243], v[68:71]
    ds_read_b64_tr_b16 v[194:195], v8 offset:1024
    ds_read_b128 a[228:231], v10 offset:18432
    v_mfma_f32_16x16x32_bf16 v[72:75], v[184:187], a[244:247], v[72:75]
    ds_read_b64_tr_b16 v[196:197], v9 offset:0
    ds_read_b128 a[232:235], v10 offset:20480
    v_mfma_f32_16x16x32_bf16 v[76:79], v[188:191], a[244:247], v[76:79]
    ds_read_b64_tr_b16 v[198:199], v9 offset:1024
    ds_read_b128 a[236:239], v10 offset:22528
    buffer_load_dwordx4 v6, s[20:23], s66 offen offset:0 lds
    v_mfma_f32_16x16x32_bf16 v[80:83], v[184:187], a[248:251], v[80:83]
    v_cmp_gt_u32 vcc, 14, v0
    s_nop 1
    v_cndmask_b32 v51, v15, v51, vcc
    v_cndmask_b32 v52, 0, v61, vcc
    v_mfma_f32_16x16x32_bf16 v[84:87], v[188:191], a[248:251], v[84:87]
    v_cmp_gt_u32 vcc, 16, v0
    s_nop 1
    v_cndmask_b32 v53, 0, v61, vcc
    v_mfma_f32_16x16x32_bf16 v[88:91], v[184:187], a[252:255], v[88:91]
    buffer_load_dwordx4 v7, s[20:23], s66 offen offset:1024 lds
    s_add_u32 m0, s88, 24576
    v_mfma_f32_16x16x32_bf16 v[92:95], v[188:191], a[252:255], v[92:95]
    s_waitcnt lgkmcnt(0)
    v_mfma_f32_16x16x32_bf16 v[64:67], v[192:195], a[224:227], v[64:67]
    ds_read_b64_tr_b16 v[200:201], v8 offset:8192
    ds_read_b128 a[240:243], v11 offset:16384
    buffer_load_dwordx4 v2, s[24:27], s59 offen offset:0 lds
    v_mfma_f32_16x16x32_bf16 v[68:71], v[196:199], a[224:227], v[68:71]
    ds_read_b64_tr_b16 v[202:203], v8 offset:9216
    ds_read_b128 a[244:247], v11 offset:18432
    v_mfma_f32_16x16x32_bf16 v[72:75], v[192:195], a[228:231], v[72:75]
    ds_read_b64_tr_b16 v[204:205], v9 offset:8192
    ds_read_b128 a[248:251], v11 offset:20480
    v_mfma_f32_16x16x32_bf16 v[76:79], v[196:199], a[228:231], v[76:79]
    ds_read_b64_tr_b16 v[206:207], v9 offset:9216
    ds_read_b128 a[252:255], v11 offset:22528
    buffer_load_dwordx4 v3, s[24:27], s59 offen offset:1024 lds
    v_mfma_f32_16x16x32_bf16 v[80:83], v[192:195], a[232:235], v[80:83]
    v_mfma_f32_16x16x32_bf16 v[84:87], v[196:199], a[232:235], v[84:87]
    v_mfma_f32_16x16x32_bf16 v[88:91], v[192:195], a[236:239], v[88:91]
    buffer_load_dwordx4 v4, s[24:27], s59 offen offset:2048 lds
    v_mfma_f32_16x16x32_bf16 v[92:95], v[196:199], a[236:239], v[92:95]
    s_waitcnt lgkmcnt(0)
    v_mfma_f32_16x16x32_bf16 v[64:67], v[200:203], a[240:243], v[64:67]
    s_waitcnt vmcnt(9)
    s_barrier
    ds_read_b64_tr_b16 v[208:209], v8 offset:24576
    ds_read_b128 a[224:227], v10 offset:40960
    buffer_load_dwordx4 v5, s[24:27], s59 offen offset:3072 lds
    s_add_u32 m0, s89, 40960
    v_mfma_f32_16x16x32_bf16 v[68:71], v[204:207], a[240:243], v[68:71]
    ds_read_b64_tr_b16 v[210:211], v8 offset:25600
    ds_read_b128 a[228:231], v10 offset:43008
    v_mfma_f32_16x16x32_bf16 v[72:75], v[200:203], a[244:247], v[72:75]
    ds_read_b64_tr_b16 v[212:213], v9 offset:24576
    ds_read_b128 a[232:235], v10 offset:45056
    v_mfma_f32_16x16x32_bf16 v[76:79], v[204:207], a[244:247], v[76:79]
    ds_read_b64_tr_b16 v[214:215], v9 offset:25600
    ds_read_b128 a[236:239], v10 offset:47104
    buffer_load_dwordx4 v6, s[20:23], s67 offen offset:0 lds
    v_mfma_f32_16x16x32_bf16 v[80:83], v[200:203], a[248:251], v[80:83]
    v_mfma_f32_16x16x32_bf16 v[84:87], v[204:207], a[248:251], v[84:87]
    v_mfma_f32_16x16x32_bf16 v[88:91], v[200:203], a[252:255], v[88:91]
    buffer_load_dwordx4 v7, s[20:23], s67 offen offset:1024 lds
    s_add_u32 m0, s89, 147456
    v_mfma_f32_16x16x32_bf16 v[92:95], v[204:207], a[252:255], v[92:95]
    s_waitcnt lgkmcnt(0)
    v_mfma_f32_16x16x32_bf16 v[64:67], v[208:211], a[224:227], v[64:67]
    ds_read_b64_tr_b16 v[216:217], v8 offset:32768
    ds_read_b128 a[240:243], v11 offset:40960
    buffer_load_dwordx4 v46, s[20:23], s60 offen offset:0 lds
    v_mfma_f32_16x16x32_bf16 v[68:71], v[212:215], a[224:227], v[68:71]
    ds_read_b64_tr_b16 v[218:219], v8 offset:33792
    ds_read_b128 a[244:247], v11 offset:43008
    v_mfma_f32_16x16x32_bf16 v[72:75], v[208:211], a[228:231], v[72:75]
    ds_read_b64_tr_b16 v[220:221], v9 offset:32768
    ds_read_b128 a[248:251], v11 offset:45056
    v_mfma_f32_16x16x32_bf16 v[76:79], v[212:215], a[228:231], v[76:79]
    ds_read_b64_tr_b16 v[222:223], v9 offset:33792
    ds_read_b128 a[252:255], v11 offset:47104
    buffer_load_dwordx4 v47, s[20:23], s60 offen offset:1024 lds
    s_add_u32 m0, s89, 155648
    v_mfma_f32_16x16x32_bf16 v[80:83], v[208:211], a[232:235], v[80:83]
    v_mfma_f32_16x16x32_bf16 v[84:87], v[212:215], a[232:235], v[84:87]
    v_mfma_f32_16x16x32_bf16 v[88:91], v[208:211], a[236:239], v[88:91]
    buffer_load_dwordx4 v46, s[20:23], s61 offen offset:0 lds
    v_mfma_f32_16x16x32_bf16 v[92:95], v[212:215], a[236:239], v[92:95]
    s_waitcnt lgkmcnt(0)
    v_mfma_f32_16x16x32_bf16 v[64:67], v[216:219], a[240:243], v[64:67]
    s_waitcnt vmcnt(9)
    s_barrier
    v_subrev_u32 v8, 98304, v8
    v_subrev_u32 v9, 98304, v9
    v_subrev_u32 v10, 98304, v10
    v_subrev_u32 v11, 98304, v11
    ds_read_b64_tr_b16 v[224:225], v8 offset:0
    ds_read_b128 a[224:227], v10 offset:16384
    buffer_load_dwordx4 v47, s[20:23], s61 offen offset:1024 lds
    s_add_u32 m0, s89, 49152
    v_mfma_f32_16x16x32_bf16 v[68:71], v[220:223], a[240:243], v[68:71]
    ds_read_b64_tr_b16 v[226:227], v8 offset:1024
    ds_read_b128 a[228:231], v10 offset:18432
    v_mfma_f32_16x16x32_bf16 v[72:75], v[216:219], a[244:247], v[72:75]
    ds_read_b64_tr_b16 v[228:229], v9 offset:0
    ds_read_b128 a[232:235], v10 offset:20480
    v_mfma_f32_16x16x32_bf16 v[76:79], v[220:223], a[244:247], v[76:79]
    ds_read_b64_tr_b16 v[230:231], v9 offset:1024
    ds_read_b128 a[236:239], v10 offset:22528
    buffer_load_dwordx4 v46, s[20:23], s62 offen offset:0 lds
    v_mfma_f32_16x16x32_bf16 v[80:83], v[216:219], a[248:251], v[80:83]
    v_mfma_f32_16x16x32_bf16 v[84:87], v[220:223], a[248:251], v[84:87]
    v_mfma_f32_16x16x32_bf16 v[88:91], v[216:219], a[252:255], v[88:91]
    buffer_load_dwordx4 v47, s[20:23], s62 offen offset:1024 lds
    s_add_u32 m0, s89, 57344
    v_mfma_f32_16x16x32_bf16 v[92:95], v[220:223], a[252:255], v[92:95]
    s_waitcnt lgkmcnt(0)
    v_mfma_f32_16x16x32_bf16 v[64:67], v[224:227], a[224:227], v[64:67]
    ds_read_b64_tr_b16 v[232:233], v8 offset:8192
    ds_read_b128 a[240:243], v11 offset:16384
    buffer_load_dwordx4 v46, s[20:23], s63 offen offset:0 lds
    v_mfma_f32_16x16x32_bf16 v[68:71], v[228:231], a[224:227], v[68:71]
    ds_read_b64_tr_b16 v[234:235], v8 offset:9216
    ds_read_b128 a[244:247], v11 offset:18432
    v_mfma_f32_16x16x32_bf16 v[72:75], v[224:227], a[228:231], v[72:75]
    ds_read_b64_tr_b16 v[236:237], v9 offset:8192
    ds_read_b128 a[248:251], v11 offset:20480
    v_mfma_f32_16x16x32_bf16 v[76:79], v[228:231], a[228:231], v[76:79]
    ds_read_b64_tr_b16 v[238:239], v9 offset:9216
    ds_read_b128 a[252:255], v11 offset:22528
    buffer_load_dwordx4 v47, s[20:23], s63 offen offset:1024 lds
    s_add_u32 m0, s89, 65536
    v_mfma_f32_16x16x32_bf16 v[80:83], v[224:227], a[232:235], v[80:83]
    v_mfma_f32_16x16x32_bf16 v[84:87], v[228:231], a[232:235], v[84:87]
    v_mfma_f32_16x16x32_bf16 v[88:91], v[224:227], a[236:239], v[88:91]
    buffer_load_dwordx4 v46, s[20:23], s64 offen offset:0 lds
    v_mfma_f32_16x16x32_bf16 v[92:95], v[228:231], a[236:239], v[92:95]
    s_waitcnt lgkmcnt(0)
    v_mfma_f32_16x16x32_bf16 v[64:67], v[232:235], a[240:243], v[64:67]
    s_waitcnt vmcnt(9)
    s_barrier
    ds_read_b64_tr_b16 v[240:241], v8 offset:24576
    ds_read_b128 a[224:227], v10 offset:40960
    buffer_load_dwordx4 v47, s[20:23], s64 offen offset:1024 lds
    s_add_u32 m0, s89, 73728
    v_mfma_f32_16x16x32_bf16 v[68:71], v[236:239], a[240:243], v[68:71]
    ds_read_b64_tr_b16 v[242:243], v8 offset:25600
    ds_read_b128 a[228:231], v10 offset:43008
    v_mfma_f32_16x16x32_bf16 v[72:75], v[232:235], a[244:247], v[72:75]
    ds_read_b64_tr_b16 v[244:245], v9 offset:24576
    ds_read_b128 a[232:235], v10 offset:45056
    v_mfma_f32_16x16x32_bf16 v[76:79], v[236:239], a[244:247], v[76:79]
    ds_read_b64_tr_b16 v[246:247], v9 offset:25600
    ds_read_b128 a[236:239], v10 offset:47104
    buffer_load_dwordx4 v46, s[20:23], s65 offen offset:0 lds
    v_mfma_f32_16x16x32_bf16 v[80:83], v[232:235], a[248:251], v[80:83]
    v_mfma_f32_16x16x32_bf16 v[84:87], v[236:239], a[248:251], v[84:87]
    v_mfma_f32_16x16x32_bf16 v[88:91], v[232:235], a[252:255], v[88:91]
    buffer_load_dwordx4 v47, s[20:23], s65 offen offset:1024 lds
    s_add_u32 m0, s89, 81920
    v_mfma_f32_16x16x32_bf16 v[92:95], v[236:239], a[252:255], v[92:95]
    s_waitcnt lgkmcnt(0)
    v_mfma_f32_16x16x32_bf16 v[64:67], v[240:243], a[224:227], v[64:67]
    ds_read_b64_tr_b16 v[248:249], v8 offset:32768
    ds_read_b128 a[240:243], v11 offset:40960
    buffer_load_dwordx4 v46, s[20:23], s66 offen offset:0 lds
    v_mfma_f32_16x16x32_bf16 v[68:71], v[244:247], a[224:227], v[68:71]
    ds_read_b64_tr_b16 v[250:251], v8 offset:33792
    ds_read_b128 a[244:247], v11 offset:43008
    v_mfma_f32_16x16x32_bf16 v[72:75], v[240:243], a[228:231], v[72:75]
    ds_read_b64_tr_b16 v[252:253], v9 offset:32768
    ds_read_b128 a[248:251], v11 offset:45056
    v_mfma_f32_16x16x32_bf16 v[76:79], v[244:247], a[228:231], v[76:79]
    ds_read_b64_tr_b16 v[254:255], v9 offset:33792
    ds_read_b128 a[252:255], v11 offset:47104
    buffer_load_dwordx4 v47, s[20:23], s66 offen offset:1024 lds
    s_add_u32 m0, s89, 90112
    v_mfma_f32_16x16x32_bf16 v[80:83], v[240:243], a[232:235], v[80:83]
    v_mfma_f32_16x16x32_bf16 v[84:87], v[244:247], a[232:235], v[84:87]
    v_mfma_f32_16x16x32_bf16 v[88:91], v[240:243], a[236:239], v[88:91]
    buffer_load_dwordx4 v46, s[20:23], s67 offen offset:0 lds
    v_mfma_f32_16x16x32_bf16 v[92:95], v[244:247], a[236:239], v[92:95]
    s_waitcnt lgkmcnt(0)
    v_mfma_f32_16x16x32_bf16 v[64:67], v[248:251], a[240:243], v[64:67]
    s_waitcnt vmcnt(11)
    s_barrier
    v_add_u32 v10, 147456, v10
    v_add_u32 v11, 147456, v11
    ds_read_b128 a[224:227], v10 offset:0
    buffer_load_dwordx4 v47, s[20:23], s67 offen offset:1024 lds
    s_add_u32 m0, s88, 98304
    v_mfma_f32_16x16x32_bf16 v[68:71], v[252:255], a[240:243], v[68:71]
    ds_read_b128 a[228:231], v10 offset:2048
    v_mfma_f32_16x16x32_bf16 v[72:75], v[248:251], a[244:247], v[72:75]
    ds_read_b128 a[232:235], v10 offset:4096
    v_mfma_f32_16x16x32_bf16 v[76:79], v[252:255], a[244:247], v[76:79]
    ds_read_b128 a[236:239], v10 offset:6144
    buffer_load_dwordx4 v36, s[28:31], s94 offen offset:0 lds
    v_mfma_f32_16x16x32_bf16 v[80:83], v[248:251], a[248:251], v[80:83]
    v_mfma_f32_16x16x32_bf16 v[84:87], v[252:255], a[248:251], v[84:87]
    v_mfma_f32_16x16x32_bf16 v[88:91], v[248:251], a[252:255], v[88:91]
    buffer_load_dwordx4 v37, s[28:31], s94 offen offset:1024 lds
    v_mfma_f32_16x16x32_bf16 v[92:95], v[252:255], a[252:255], v[92:95]
    s_waitcnt lgkmcnt(0)
    v_mfma_f32_16x16x32_bf16 v[96:99], v[128:131], a[224:227], v[16:19]
    ds_read_b128 a[240:243], v11 offset:0
    v_mfma_f32_16x16x32_bf16 v[100:103], v[132:135], a[224:227], v[20:23]
    ds_read_b128 a[244:247], v11 offset:2048
    v_mfma_f32_16x16x32_bf16 v[104:107], v[128:131], a[228:231], v[16:19]
    ds_read_b128 a[248:251], v11 offset:4096
    v_mfma_f32_16x16x32_bf16 v[108:111], v[132:135], a[228:231], v[20:23]
    ds_read_b128 a[252:255], v11 offset:6144
    buffer_load_dwordx4 v38, s[28:31], s94 offen offset:2048 lds
    v_mfma_f32_16x16x32_bf16 v[112:115], v[128:131], a[232:235], v[16:19]
    v_mfma_f32_16x16x32_bf16 v[116:119], v[132:135], a[232:235], v[20:23]
    v_max_f32 v64, 0, v64
    v_max_f32 v65, 0, v65
    v_mfma_f32_16x16x32_bf16 v[120:123], v[128:131], a[236:239], v[16:19]
    v_max_f32 v66, 0, v66
    v_max_f32 v67, 0, v67
    v_mfma_f32_16x16x32_bf16 v[124:127], v[132:135], a[236:239], v[20:23]
    buffer_load_dwordx4 v39, s[28:31], s94 offen offset:3072 lds
    s_add_u32 s94, s94, 32768
    s_add_u32 m0, s88, 114688
    s_waitcnt lgkmcnt(0)
    v_mfma_f32_16x16x32_bf16 v[96:99], v[136:139], a[240:243], v[96:99]
    ds_read_b128 a[224:227], v10 offset:8192
    v_max_f32 v68, 0, v68
    v_mfma_f32_16x16x32_bf16 v[100:103], v[140:143], a[240:243], v[100:103]
    ds_read_b128 a[228:231], v10 offset:10240
    v_max_f32 v69, 0, v69
    v_mfma_f32_16x16x32_bf16 v[104:107], v[136:139], a[244:247], v[104:107]
    ds_read_b128 a[232:235], v10 offset:12288
    v_max_f32 v70, 0, v70
    v_mfma_f32_16x16x32_bf16 v[108:111], v[140:143], a[244:247], v[108:111]
    ds_read_b128 a[236:239], v10 offset:14336
    buffer_load_dwordx4 v36, s[28:31], s94 offen offset:0 lds
    v_mfma_f32_16x16x32_bf16 v[112:115], v[136:139], a[248:251], v[112:115]
    v_max_f32 v71, 0, v71
    v_mul_f32 v64, v64, v64
    v_mfma_f32_16x16x32_bf16 v[116:119], v[140:143], a[248:251], v[116:119]
    v_mul_f32 v65, v65, v65
    v_mul_f32 v66, v66, v66
    v_mfma_f32_16x16x32_bf16 v[120:123], v[136:139], a[252:255], v[120:123]
    v_mul_f32 v67, v67, v67
    v_mul_f32 v68, v68, v68
    v_mfma_f32_16x16x32_bf16 v[124:127], v[140:143], a[252:255], v[124:127]
    buffer_load_dwordx4 v37, s[28:31], s94 offen offset:1024 lds
    s_waitcnt lgkmcnt(0)
    v_mfma_f32_16x16x32_bf16 v[96:99], v[144:147], a[224:227], v[96:99]
    ds_read_b128 a[240:243], v11 offset:8192
    v_mul_f32 v69, v69, v69
    v_mfma_f32_16x16x32_bf16 v[100:103], v[148:151], a[224:227], v[100:103]
    ds_read_b128 a[244:247], v11 offset:10240
    v_mul_f32 v70, v70, v70
    v_mfma_f32_16x16x32_bf16 v[104:107], v[144:147], a[228:231], v[104:107]
    ds_read_b128 a[248:251], v11 offset:12288
    v_mul_f32 v71, v71, v71
    v_mfma_f32_16x16x32_bf16 v[108:111], v[148:151], a[228:231], v[108:111]
    ds_read_b128 a[252:255], v11 offset:14336
    v_cvt_pk_bf16_f32 v64, v64, v65
    v_cvt_pk_bf16_f32 v65, v66, v67
    v_cvt_pk_bf16_f32 v66, v68, v69
    v_cvt_pk_bf16_f32 v67, v70, v71
    buffer_store_dwordx4 v[64:67], v1, s[32:35], s92 offen sc1
    v_mfma_f32_16x16x32_bf16 v[112:115], v[144:147], a[232:235], v[112:115]
    v_max_f32 v72, 0, v72
    v_max_f32 v73, 0, v73
    v_mfma_f32_16x16x32_bf16 v[116:119], v[148:151], a[232:235], v[116:119]
    v_max_f32 v74, 0, v74
    v_max_f32 v75, 0, v75
    v_mfma_f32_16x16x32_bf16 v[120:123], v[144:147], a[236:239], v[120:123]
    v_max_f32 v76, 0, v76
    v_max_f32 v77, 0, v77
    v_mfma_f32_16x16x32_bf16 v[124:127], v[148:151], a[236:239], v[124:127]
    buffer_load_dwordx4 v38, s[28:31], s94 offen offset:2048 lds
    s_waitcnt lgkmcnt(0)
    v_mfma_f32_16x16x32_bf16 v[96:99], v[152:155], a[240:243], v[96:99]
    s_waitcnt vmcnt(16)
    s_barrier
    v_subrev_u32 v10, 98304, v10
    v_subrev_u32 v11, 98304, v11
    ds_read_b128 a[224:227], v10 offset:0
    v_max_f32 v78, 0, v78
    v_mfma_f32_16x16x32_bf16 v[100:103], v[156:159], a[240:243], v[100:103]
    ds_read_b128 a[228:231], v10 offset:2048
    v_max_f32 v79, 0, v79
    v_mfma_f32_16x16x32_bf16 v[104:107], v[152:155], a[244:247], v[104:107]
    ds_read_b128 a[232:235], v10 offset:4096
    v_mul_f32 v72, v72, v72
    v_mfma_f32_16x16x32_bf16 v[108:111], v[156:159], a[244:247], v[108:111]
    ds_read_b128 a[236:239], v10 offset:6144
    buffer_load_dwordx4 v39, s[28:31], s94 offen offset:3072 lds
    s_add_u32 s94, s94, 32768
    s_add_u32 m0, s88, 131072
    v_mfma_f32_16x16x32_bf16 v[112:115], v[152:155], a[248:251], v[112:115]
    v_mul_f32 v73, v73, v73
    v_mul_f32 v74, v74, v74
    v_mfma_f32_16x16x32_bf16 v[116:119], v[156:159], a[248:251], v[116:119]
    v_mul_f32 v75, v75, v75
    v_mul_f32 v76, v76, v76
    v_mfma_f32_16x16x32_bf16 v[120:123], v[152:155], a[252:255], v[120:123]
    v_mul_f32 v77, v77, v77
    v_mul_f32 v78, v78, v78
    v_mfma_f32_16x16x32_bf16 v[124:127], v[156:159], a[252:255], v[124:127]
    buffer_load_dwordx4 v36, s[28:31], s94 offen offset:0 lds
    s_waitcnt lgkmcnt(0)
    v_mfma_f32_16x16x32_bf16 v[96:99], v[160:163], a[224:227], v[96:99]
    ds_read_b128 a[240:243], v11 offset:0
    v_mul_f32 v79, v79, v79
    v_mfma_f32_16x16x32_bf16 v[100:103], v[164:167], a[224:227], v[100:103]
    ds_read_b128 a[244:247], v11 offset:2048
    v_cvt_pk_bf16_f32 v72, v72, v73
    v_mfma_f32_16x16x32_bf16 v[104:107], v[160:163], a[228:231], v[104:107]
    ds_read_b128 a[248:251], v11 offset:4096
    v_cvt_pk_bf16_f32 v73, v74, v75
    v_mfma_f32_16x16x32_bf16 v[108:111], v[164:167], a[228:231], v[108:111]
    ds_read_b128 a[252:255], v11 offset:6144
    buffer_load_dwordx4 v37, s[28:31], s94 offen offset:1024 lds
    v_mfma_f32_16x16x32_bf16 v[112:115], v[160:163], a[232:235], v[112:115]
    v_cvt_pk_bf16_f32 v74, v76, v77
    v_cvt_pk_bf16_f32 v75, v78, v79
    v_mfma_f32_16x16x32_bf16 v[116:119], v[164:167], a[232:235], v[116:119]
    v_max_f32 v80, 0, v80
    v_max_f32 v81, 0, v81
    v_mfma_f32_16x16x32_bf16 v[120:123], v[160:163], a[236:239], v[120:123]
    v_max_f32 v82, 0, v82
    v_max_f32 v83, 0, v83
    v_mfma_f32_16x16x32_bf16 v[124:127], v[164:167], a[236:239], v[124:127]
    buffer_load_dwordx4 v38, s[28:31], s94 offen offset:2048 lds
    s_waitcnt lgkmcnt(0)
    v_mfma_f32_16x16x32_bf16 v[96:99], v[168:171], a[240:243], v[96:99]
    ds_read_b128 a[224:227], v10 offset:8192
    v_max_f32 v84, 0, v84
    v_mfma_f32_16x16x32_bf16 v[100:103], v[172:175], a[240:243], v[100:103]
    ds_read_b128 a[228:231], v10 offset:10240
    v_max_f32 v85, 0, v85
    v_mfma_f32_16x16x32_bf16 v[104:107], v[168:171], a[244:247], v[104:107]
    ds_read_b128 a[232:235], v10 offset:12288
    v_max_f32 v86, 0, v86
    v_mfma_f32_16x16x32_bf16 v[108:111], v[172:175], a[244:247], v[108:111]
    ds_read_b128 a[236:239], v10 offset:14336
    s_add_u32 s92, s92, 57344
    buffer_store_dwordx4 v[72:75], v1, s[32:35], s92 offen sc1
    v_mfma_f32_16x16x32_bf16 v[112:115], v[168:171], a[248:251], v[112:115]
    v_max_f32 v87, 0, v87
    v_mul_f32 v80, v80, v80
    v_mfma_f32_16x16x32_bf16 v[116:119], v[172:175], a[248:251], v[116:119]
    v_mul_f32 v81, v81, v81
    v_mul_f32 v82, v82, v82
    v_mfma_f32_16x16x32_bf16 v[120:123], v[168:171], a[252:255], v[120:123]
    v_mul_f32 v83, v83, v83
    v_mul_f32 v84, v84, v84
    v_mfma_f32_16x16x32_bf16 v[124:127], v[172:175], a[252:255], v[124:127]
    buffer_load_dwordx4 v39, s[28:31], s94 offen offset:3072 lds
    s_add_u32 s94, s94, 32768
    s_add_u32 m0, s88, 0
    s_waitcnt lgkmcnt(0)
    v_mfma_f32_16x16x32_bf16 v[96:99], v[176:179], a[224:227], v[96:99]
    ds_read_b128 a[240:243], v11 offset:8192
    v_mul_f32 v85, v85, v85
    v_mfma_f32_16x16x32_bf16 v[100:103], v[180:183], a[224:227], v[100:103]
    ds_read_b128 a[244:247], v11 offset:10240
    v_mul_f32 v86, v86, v86
    v_mfma_f32_16x16x32_bf16 v[104:107], v[176:179], a[228:231], v[104:107]
    ds_read_b128 a[248:251], v11 offset:12288
    v_mul_f32 v87, v87, v87
    v_mfma_f32_16x16x32_bf16 v[108:111], v[180:183], a[228:231], v[108:111]
    ds_read_b128 a[252:255], v11 offset:14336
    buffer_load_dwordx4 v36, s[28:31], s94 offen offset:0 lds
    v_mfma_f32_16x16x32_bf16 v[112:115], v[176:179], a[232:235], v[112:115]
    v_cvt_pk_bf16_f32 v80, v80, v81
    v_cvt_pk_bf16_f32 v81, v82, v83
    v_mfma_f32_16x16x32_bf16 v[116:119], v[180:183], a[232:235], v[116:119]
    v_cvt_pk_bf16_f32 v82, v84, v85
    v_cvt_pk_bf16_f32 v83, v86, v87
    v_mfma_f32_16x16x32_bf16 v[120:123], v[176:179], a[236:239], v[120:123]
    v_max_f32 v88, 0, v88
    v_max_f32 v89, 0, v89
    v_mfma_f32_16x16x32_bf16 v[124:127], v[180:183], a[236:239], v[124:127]
    buffer_load_dwordx4 v37, s[28:31], s94 offen offset:1024 lds
    s_waitcnt lgkmcnt(0)
    v_mfma_f32_16x16x32_bf16 v[96:99], v[184:187], a[240:243], v[96:99]
    s_waitcnt vmcnt(20)
    s_barrier
    ds_read_b128 a[224:227], v10 offset:16384
    v_max_f32 v90, 0, v90
    v_mfma_f32_16x16x32_bf16 v[100:103], v[188:191], a[240:243], v[100:103]
    ds_read_b128 a[228:231], v10 offset:18432
    v_max_f32 v91, 0, v91
    v_mfma_f32_16x16x32_bf16 v[104:107], v[184:187], a[244:247], v[104:107]
    ds_read_b128 a[232:235], v10 offset:20480
    v_max_f32 v92, 0, v92
    v_mfma_f32_16x16x32_bf16 v[108:111], v[188:191], a[244:247], v[108:111]
    ds_read_b128 a[236:239], v10 offset:22528
    buffer_load_dwordx4 v38, s[28:31], s94 offen offset:2048 lds
    v_mfma_f32_16x16x32_bf16 v[112:115], v[184:187], a[248:251], v[112:115]
    v_max_f32 v93, 0, v93
    v_max_f32 v94, 0, v94
    v_mfma_f32_16x16x32_bf16 v[116:119], v[188:191], a[248:251], v[116:119]
    v_max_f32 v95, 0, v95
    v_mul_f32 v88, v88, v88
    v_mfma_f32_16x16x32_bf16 v[120:123], v[184:187], a[252:255], v[120:123]
    v_mul_f32 v89, v89, v89
    v_mul_f32 v90, v90, v90
    v_mfma_f32_16x16x32_bf16 v[124:127], v[188:191], a[252:255], v[124:127]
    buffer_load_dwordx4 v39, s[28:31], s94 offen offset:3072 lds
    s_add_u32 s94, s94, 32768
    s_add_u32 m0, s88, 16384
    s_waitcnt lgkmcnt(0)
    v_mfma_f32_16x16x32_bf16 v[96:99], v[192:195], a[224:227], v[96:99]
    ds_read_b128 a[240:243], v11 offset:16384
    v_mul_f32 v91, v91, v91
    v_mfma_f32_16x16x32_bf16 v[100:103], v[196:199], a[224:227], v[100:103]
    ds_read_b128 a[244:247], v11 offset:18432
    v_mul_f32 v92, v92, v92
    v_mfma_f32_16x16x32_bf16 v[104:107], v[192:195], a[228:231], v[104:107]
    ds_read_b128 a[248:251], v11 offset:20480
    v_mul_f32 v93, v93, v93
    v_mfma_f32_16x16x32_bf16 v[108:111], v[196:199], a[228:231], v[108:111]
    ds_read_b128 a[252:255], v11 offset:22528
    s_add_u32 s92, s92, 57344
    buffer_store_dwordx4 v[80:83], v1, s[32:35], s92 offen sc1
    v_mfma_f32_16x16x32_bf16 v[112:115], v[192:195], a[232:235], v[112:115]
    v_mul_f32 v94, v94, v94
    v_mul_f32 v95, v95, v95
    v_mfma_f32_16x16x32_bf16 v[116:119], v[196:199], a[232:235], v[116:119]
    v_cvt_pk_bf16_f32 v88, v88, v89
    v_cvt_pk_bf16_f32 v89, v90, v91
    v_mfma_f32_16x16x32_bf16 v[120:123], v[192:195], a[236:239], v[120:123]
    v_cvt_pk_bf16_f32 v90, v92, v93
    v_cvt_pk_bf16_f32 v91, v94, v95
    v_mfma_f32_16x16x32_bf16 v[124:127], v[196:199], a[236:239], v[124:127]
    buffer_load_dwordx4 v36, s[28:31], s94 offen offset:0 lds
    s_waitcnt lgkmcnt(0)
    v_mfma_f32_16x16x32_bf16 v[96:99], v[200:203], a[240:243], v[96:99]
    ds_read_b128 a[224:227], v10 offset:24576
    v_mfma_f32_16x16x32_bf16 v[100:103], v[204:207], a[240:243], v[100:103]
    ds_read_b128 a[228:231], v10 offset:26624
    v_mfma_f32_16x16x32_bf16 v[104:107], v[200:203], a[244:247], v[104:107]
    ds_read_b128 a[232:235], v10 offset:28672
    v_mfma_f32_16x16x32_bf16 v[108:111], v[204:207], a[244:247], v[108:111]
    ds_read_b128 a[236:239], v10 offset:30720
    buffer_load_dwordx4 v37, s[28:31], s94 offen offset:1024 lds
    v_mfma_f32_16x16x32_bf16 v[112:115], v[200:203], a[248:251], v[112:115]
    v_mfma_f32_16x16x32_bf16 v[116:119], v[204:207], a[248:251], v[116:119]
    v_mfma_f32_16x16x32_bf16 v[120:123], v[200:203], a[252:255], v[120:123]
    v_mfma_f32_16x16x32_bf16 v[124:127], v[204:207], a[252:255], v[124:127]
    buffer_load_dwordx4 v38, s[28:31], s94 offen offset:2048 lds
    s_waitcnt lgkmcnt(0)
    v_mfma_f32_16x16x32_bf16 v[96:99], v[208:211], a[224:227], v[96:99]
    ds_read_b128 a[240:243], v11 offset:24576
    v_mfma_f32_16x16x32_bf16 v[100:103], v[212:215], a[224:227], v[100:103]
    ds_read_b128 a[244:247], v11 offset:26624
    v_mfma_f32_16x16x32_bf16 v[104:107], v[208:211], a[228:231], v[104:107]
    ds_read_b128 a[248:251], v11 offset:28672
    v_mfma_f32_16x16x32_bf16 v[108:111], v[212:215], a[228:231], v[108:111]
    ds_read_b128 a[252:255], v11 offset:30720
    buffer_load_dwordx4 v39, s[28:31], s94 offen offset:3072 lds
    s_add_u32 s94, s94, 32768
    s_add_u32 m0, s88, 32768
    v_mfma_f32_16x16x32_bf16 v[112:115], v[208:211], a[232:235], v[112:115]
    v_mfma_f32_16x16x32_bf16 v[116:119], v[212:215], a[232:235], v[116:119]
    v_mfma_f32_16x16x32_bf16 v[120:123], v[208:211], a[236:239], v[120:123]
    v_mfma_f32_16x16x32_bf16 v[124:127], v[212:215], a[236:239], v[124:127]
    buffer_load_dwordx4 v36, s[28:31], s94 offen offset:0 lds
    s_waitcnt lgkmcnt(0)
    v_mfma_f32_16x16x32_bf16 v[96:99], v[216:219], a[240:243], v[96:99]
    s_waitcnt vmcnt(24)
    s_barrier
    ds_read_b128 a[224:227], v10 offset:32768
    v_mfma_f32_16x16x32_bf16 v[100:103], v[220:223], a[240:243], v[100:103]
    ds_read_b128 a[228:231], v10 offset:34816
    v_mfma_f32_16x16x32_bf16 v[104:107], v[216:219], a[244:247], v[104:107]
    ds_read_b128 a[232:235], v10 offset:36864
    v_mfma_f32_16x16x32_bf16 v[108:111], v[220:223], a[244:247], v[108:111]
    ds_read_b128 a[236:239], v10 offset:38912
    s_add_u32 s92, s92, 57344
    buffer_store_dwordx4 v[88:91], v1, s[32:35], s92 offen sc1
    buffer_load_dword v28, v54, s[40:43], 0 offen sc1
    v_mfma_f32_16x16x32_bf16 v[112:115], v[216:219], a[248:251], v[112:115]
    v_mfma_f32_16x16x32_bf16 v[116:119], v[220:223], a[248:251], v[116:119]
    v_mfma_f32_16x16x32_bf16 v[120:123], v[216:219], a[252:255], v[120:123]
    v_mfma_f32_16x16x32_bf16 v[124:127], v[220:223], a[252:255], v[124:127]
    buffer_load_dwordx4 v37, s[28:31], s94 offen offset:1024 lds
    s_waitcnt lgkmcnt(0)
    v_mfma_f32_16x16x32_bf16 v[96:99], v[224:227], a[224:227], v[96:99]
    ds_read_b128 a[240:243], v11 offset:32768
    v_mfma_f32_16x16x32_bf16 v[100:103], v[228:231], a[224:227], v[100:103]
    ds_read_b128 a[244:247], v11 offset:34816
    v_mfma_f32_16x16x32_bf16 v[104:107], v[224:227], a[228:231], v[104:107]
    ds_read_b128 a[248:251], v11 offset:36864
    v_mfma_f32_16x16x32_bf16 v[108:111], v[228:231], a[228:231], v[108:111]
    ds_read_b128 a[252:255], v11 offset:38912
    buffer_load_dwordx4 v38, s[28:31], s94 offen offset:2048 lds
    v_mfma_f32_16x16x32_bf16 v[112:115], v[224:227], a[232:235], v[112:115]
    v_mfma_f32_16x16x32_bf16 v[116:119], v[228:231], a[232:235], v[116:119]
    v_mfma_f32_16x16x32_bf16 v[120:123], v[224:227], a[236:239], v[120:123]
    v_mfma_f32_16x16x32_bf16 v[124:127], v[228:231], a[236:239], v[124:127]
    buffer_load_dwordx4 v39, s[28:31], s94 offen offset:3072 lds
    s_add_u32 s94, s94, 32768
    s_add_u32 m0, s88, 147456
    s_waitcnt lgkmcnt(0)
    v_mfma_f32_16x16x32_bf16 v[96:99], v[232:235], a[240:243], v[96:99]
    ds_read_b128 a[224:227], v10 offset:40960
    v_mfma_f32_16x16x32_bf16 v[100:103], v[236:239], a[240:243], v[100:103]
    ds_read_b128 a[228:231], v10 offset:43008
    v_mfma_f32_16x16x32_bf16 v[104:107], v[232:235], a[244:247], v[104:107]
    ds_read_b128 a[232:235], v10 offset:45056
    v_mfma_f32_16x16x32_bf16 v[108:111], v[236:239], a[244:247], v[108:111]
    ds_read_b128 a[236:239], v10 offset:47104
    buffer_load_dwordx4 v36, s[28:31], s94 offen offset:0 lds
    v_mfma_f32_16x16x32_bf16 v[112:115], v[232:235], a[248:251], v[112:115]
    v_mfma_f32_16x16x32_bf16 v[116:119], v[236:239], a[248:251], v[116:119]
    v_mfma_f32_16x16x32_bf16 v[120:123], v[232:235], a[252:255], v[120:123]
    v_mfma_f32_16x16x32_bf16 v[124:127], v[236:239], a[252:255], v[124:127]
    buffer_load_dwordx4 v37, s[28:31], s94 offen offset:1024 lds
    s_waitcnt lgkmcnt(0)
    v_mfma_f32_16x16x32_bf16 v[96:99], v[240:243], a[224:227], v[96:99]
    ds_read_b128 a[240:243], v11 offset:40960
    v_mfma_f32_16x16x32_bf16 v[100:103], v[244:247], a[224:227], v[100:103]
    ds_read_b128 a[244:247], v11 offset:43008
    v_mfma_f32_16x16x32_bf16 v[104:107], v[240:243], a[228:231], v[104:107]
    ds_read_b128 a[248:251], v11 offset:45056
    v_mfma_f32_16x16x32_bf16 v[108:111], v[244:247], a[228:231], v[108:111]
    ds_read_b128 a[252:255], v11 offset:47104
    buffer_load_dwordx4 v38, s[28:31], s94 offen offset:2048 lds
    v_mfma_f32_16x16x32_bf16 v[112:115], v[240:243], a[232:235], v[112:115]
    v_mfma_f32_16x16x32_bf16 v[116:119], v[244:247], a[232:235], v[116:119]
    v_mfma_f32_16x16x32_bf16 v[120:123], v[240:243], a[236:239], v[120:123]
    v_mfma_f32_16x16x32_bf16 v[124:127], v[244:247], a[236:239], v[124:127]
    buffer_load_dwordx4 v39, s[28:31], s94 offen offset:3072 lds
    s_add_u32 s94, s94, s95
    s_waitcnt lgkmcnt(0)
    v_mfma_f32_16x16x32_bf16 v[96:99], v[248:251], a[240:243], v[96:99]
    v_mfma_f32_16x16x32_bf16 v[100:103], v[252:255], a[240:243], v[100:103]
    v_mfma_f32_16x16x32_bf16 v[104:107], v[248:251], a[244:247], v[104:107]
    v_mfma_f32_16x16x32_bf16 v[108:111], v[252:255], a[244:247], v[108:111]
    v_mfma_f32_16x16x32_bf16 v[112:115], v[248:251], a[248:251], v[112:115]
    v_mfma_f32_16x16x32_bf16 v[116:119], v[252:255], a[248:251], v[116:119]
    v_mfma_f32_16x16x32_bf16 v[120:123], v[248:251], a[252:255], v[120:123]
    v_mfma_f32_16x16x32_bf16 v[124:127], v[252:255], a[252:255], v[124:127]
    v_add_u32 v6, s88, v48
    v_xor_b32 v7, 32, v6
    v_xor_b32 v8, 64, v6
    v_xor_b32 v9, 96, v6
    v_add_u32 v2, 98304, v6
    v_add_u32 v3, 98304, v7
    v_add_u32 v4, 98304, v8
    v_add_u32 v5, 98304, v9
    s_add_u32 m0, s88, 98304
    s_waitcnt vmcnt(29)
    ds_read_b64_tr_b16 a[0:1], v2 offset:0
    ds_read_b64_tr_b16 a[2:3], v2 offset:2048
    ds_read_b64_tr_b16 a[4:5], v3 offset:0
    ds_read_b64_tr_b16 a[6:7], v3 offset:2048
    ds_read_b64_tr_b16 a[8:9], v4 offset:0
    ds_read_b64_tr_b16 a[10:11], v4 offset:2048
    ds_read_b64_tr_b16 a[12:13], v5 offset:0
    ds_read_b64_tr_b16 a[14:15], v5 offset:2048
    v_max_f32 v96, 0, v96
    v_max_f32 v97, 0, v97
    v_max_f32 v98, 0, v98
    v_max_f32 v99, 0, v99
    v_max_f32 v100, 0, v100
    v_max_f32 v101, 0, v101
    v_max_f32 v102, 0, v102
    v_max_f32 v103, 0, v103
    v_mul_f32 v96, v96, v96
    v_mul_f32 v97, v97, v97
    v_mul_f32 v98, v98, v98
    v_mul_f32 v99, v99, v99
    v_mul_f32 v100, v100, v100
    v_mul_f32 v101, v101, v101
    v_mul_f32 v102, v102, v102
    v_mul_f32 v103, v103, v103
    v_cvt_pk_bf16_f32 v96, v96, v97
    v_cvt_pk_bf16_f32 v97, v98, v99
    v_cvt_pk_bf16_f32 v98, v100, v101
    v_cvt_pk_bf16_f32 v99, v102, v103
    s_waitcnt vmcnt(24)
    ds_read_b64_tr_b16 a[16:17], v2 offset:16384
    ds_read_b64_tr_b16 a[18:19], v2 offset:18432
    ds_read_b64_tr_b16 a[20:21], v3 offset:16384
    ds_read_b64_tr_b16 a[22:23], v3 offset:18432
    ds_read_b64_tr_b16 a[24:25], v4 offset:16384
    ds_read_b64_tr_b16 a[26:27], v4 offset:18432
    ds_read_b64_tr_b16 a[28:29], v5 offset:16384
    ds_read_b64_tr_b16 a[30:31], v5 offset:18432
    s_waitcnt vmcnt(8)
    s_waitcnt vmcnt(7)
    v_cmp_ne_u32 vcc, v28, v53
    s_cbranch_vccnz L_rdy_retry
L_rdy_ok:
    buffer_store_dword v61, v50, s[32:35], 0 offen offset:0 sc1
    s_waitcnt lgkmcnt(8)
    buffer_load_dwordx4 v36, s[28:31], s94 offen offset:0 lds
    v_max_f32 v104, 0, v104
    v_max_f32 v105, 0, v105
    v_max_f32 v106, 0, v106
    v_max_f32 v107, 0, v107
    v_max_f32 v108, 0, v108
    v_max_f32 v109, 0, v109
    v_max_f32 v110, 0, v110
    v_max_f32 v111, 0, v111
    buffer_load_dwordx4 v37, s[28:31], s94 offen offset:1024 lds
    s_add_u32 s92, s92, 57344
    buffer_store_dwordx4 v[96:99], v1, s[32:35], s92 offen sc1
    v_mul_f32 v104, v104, v104
    v_mul_f32 v105, v105, v105
    v_mul_f32 v106, v106, v106
    v_mul_f32 v107, v107, v107
    v_mul_f32 v108, v108, v108
    v_mul_f32 v109, v109, v109
    v_mul_f32 v110, v110, v110
    v_mul_f32 v111, v111, v111
    buffer_load_dwordx4 v38, s[28:31], s94 offen offset:2048 lds
    v_cvt_pk_bf16_f32 v104, v104, v105
    v_cvt_pk_bf16_f32 v105, v106, v107
    v_cvt_pk_bf16_f32 v106, v108, v109
    v_cvt_pk_bf16_f32 v107, v110, v111
    v_max_f32 v112, 0, v112
    v_max_f32 v113, 0, v113
    v_max_f32 v114, 0, v114
    v_max_f32 v115, 0, v115
    buffer_load_dwordx4 v39, s[28:31], s94 offen offset:3072 lds
    s_add_u32 s94, s94, 32768
    s_add_u32 m0, s88, 114688
    s_add_u32 s92, s92, 57344
    buffer_store_dwordx4 v[104:107], v1, s[32:35], s92 offen sc1
    v_max_f32 v116, 0, v116
    v_max_f32 v117, 0, v117
    v_max_f32 v118, 0, v118
    v_max_f32 v119, 0, v119
    v_mul_f32 v112, v112, v112
    v_mul_f32 v113, v113, v113
    v_mul_f32 v114, v114, v114
    v_mul_f32 v115, v115, v115
    ds_read_b64_tr_b16 a[32:33], v2 offset:32768
    ds_read_b64_tr_b16 a[34:35], v2 offset:34816
    ds_read_b64_tr_b16 a[36:37], v3 offset:32768
    ds_read_b64_tr_b16 a[38:39], v3 offset:34816
    ds_read_b64_tr_b16 a[40:41], v4 offset:32768
    ds_read_b64_tr_b16 a[42:43], v4 offset:34816
    ds_read_b64_tr_b16 a[44:45], v5 offset:32768
    ds_read_b64_tr_b16 a[46:47], v5 offset:34816
    s_waitcnt lgkmcnt(8)
    buffer_load_dwordx4 v36, s[28:31], s94 offen offset:0 lds
    v_mul_f32 v116, v116, v116
    v_mul_f32 v117, v117, v117
    v_mul_f32 v118, v118, v118
    v_mul_f32 v119, v119, v119
    v_cvt_pk_bf16_f32 v112, v112, v113
    v_cvt_pk_bf16_f32 v113, v114, v115
    v_cvt_pk_bf16_f32 v114, v116, v117
    v_cvt_pk_bf16_f32 v115, v118, v119
    buffer_load_dwordx4 v37, s[28:31], s94 offen offset:1024 lds
    s_add_u32 s92, s92, 57344
    buffer_store_dwordx4 v[112:115], v1, s[32:35], s92 offen sc1
    v_max_f32 v120, 0, v120
    v_max_f32 v121, 0, v121
    v_max_f32 v122, 0, v122
    v_max_f32 v123, 0, v123
    v_max_f32 v124, 0, v124
    v_max_f32 v125, 0, v125
    v_max_f32 v126, 0, v126
    v_max_f32 v127, 0, v127
    buffer_load_dwordx4 v38, s[28:31], s94 offen offset:2048 lds
    v_mul_f32 v120, v120, v120
    v_mul_f32 v121, v121, v121
    v_mul_f32 v122, v122, v122
    v_mul_f32 v123, v123, v123
    v_mul_f32 v124, v124, v124
    v_mul_f32 v125, v125, v125
    v_mul_f32 v126, v126, v126
    v_mul_f32 v127, v127, v127
    buffer_load_dwordx4 v39, s[28:31], s94 offen offset:3072 lds
    s_add_u32 s94, s94, 32768
    s_add_u32 m0, s88, 131072
    v_cvt_pk_bf16_f32 v120, v120, v121
    v_cvt_pk_bf16_f32 v121, v122, v123
    v_cvt_pk_bf16_f32 v122, v124, v125
    v_cvt_pk_bf16_f32 v123, v126, v127
    s_add_u32 s92, s92, 57344
    buffer_store_dwordx4 v[120:123], v1, s[32:35], s92 offen sc1
    ds_read_b64_tr_b16 a[48:49], v6 offset:0
    ds_read_b64_tr_b16 a[50:51], v6 offset:2048
    ds_read_b64_tr_b16 a[52:53], v7 offset:0
    ds_read_b64_tr_b16 a[54:55], v7 offset:2048
    ds_read_b64_tr_b16 a[56:57], v8 offset:0
    ds_read_b64_tr_b16 a[58:59], v8 offset:2048
    ds_read_b64_tr_b16 a[60:61], v9 offset:0
    ds_read_b64_tr_b16 a[62:63], v9 offset:2048
    s_waitcnt lgkmcnt(8)
    buffer_load_dwordx4 v36, s[28:31], s94 offen offset:0 lds
    buffer_load_dwordx4 v37, s[28:31], s94 offen offset:1024 lds
    buffer_load_dwordx4 v38, s[28:31], s94 offen offset:2048 lds
    buffer_load_dwordx4 v39, s[28:31], s94 offen offset:3072 lds
    s_add_u32 s94, s94, 32768
    s_add_u32 m0, s88, 0
    ds_read_b64_tr_b16 a[64:65], v6 offset:16384
    ds_read_b64_tr_b16 a[66:67], v6 offset:18432
    ds_read_b64_tr_b16 a[68:69], v7 offset:16384
    ds_read_b64_tr_b16 a[70:71], v7 offset:18432
    ds_read_b64_tr_b16 a[72:73], v8 offset:16384
    ds_read_b64_tr_b16 a[74:75], v8 offset:18432
    ds_read_b64_tr_b16 a[76:77], v9 offset:16384
    ds_read_b64_tr_b16 a[78:79], v9 offset:18432
    s_waitcnt lgkmcnt(8)
    buffer_load_dwordx4 v36, s[28:31], s94 offen offset:0 lds
    buffer_load_dwordx4 v37, s[28:31], s94 offen offset:1024 lds
    buffer_load_dwordx4 v38, s[28:31], s94 offen offset:2048 lds
    buffer_load_dwordx4 v39, s[28:31], s94 offen offset:3072 lds
    s_add_u32 s94, s94, 32768
    s_add_u32 m0, s88, 16384
    s_waitcnt vmcnt(25)
    ds_read_b64_tr_b16 a[80:81], v6 offset:32768
    ds_read_b64_tr_b16 a[82:83], v6 offset:34816
    ds_read_b64_tr_b16 a[84:85], v7 offset:32768
    ds_read_b64_tr_b16 a[86:87], v7 offset:34816
    ds_read_b64_tr_b16 a[88:89], v8 offset:32768
    ds_read_b64_tr_b16 a[90:91], v8 offset:34816
    ds_read_b64_tr_b16 a[92:93], v9 offset:32768
    ds_read_b64_tr_b16 a[94:95], v9 offset:34816
    s_waitcnt lgkmcnt(8)
    buffer_load_dwordx4 v36, s[28:31], s94 offen offset:0 lds
    buffer_load_dwordx4 v37, s[28:31], s94 offen offset:1024 lds
    buffer_load_dwordx4 v38, s[28:31], s94 offen offset:2048 lds
    buffer_load_dwordx4 v39, s[28:31], s94 offen offset:3072 lds
    s_add_u32 s94, s94, 32768
    s_add_u32 m0, s88, 32768
    s_waitcnt vmcnt(12)
    buffer_store_dword v61, v50, s[32:35], 0 offen offset:512 sc1
    s_load_dwordx16 s[52:67], s[0:1], 0
    ds_read_b64_tr_b16 a[96:97], v2 offset:49152
    ds_read_b64_tr_b16 a[98:99], v2 offset:51200
    ds_read_b64_tr_b16 a[100:101], v3 offset:49152
    ds_read_b64_tr_b16 a[102:103], v3 offset:51200
    ds_read_b64_tr_b16 a[104:105], v4 offset:49152
    ds_read_b64_tr_b16 a[106:107], v4 offset:51200
    ds_read_b64_tr_b16 a[108:109], v5 offset:49152
    ds_read_b64_tr_b16 a[110:111], v5 offset:51200
    s_waitcnt lgkmcnt(8)
    buffer_load_dwordx4 v36, s[28:31], s94 offen offset:0 lds
    buffer_load_dwordx4 v37, s[28:31], s94 offen offset:1024 lds
    buffer_load_dwordx4 v38, s[28:31], s94 offen offset:2048 lds
    buffer_load_dwordx4 v39, s[28:31], s94 offen offset:3072 lds
    s_add_u32 s94, s94, 32768
    s_add_u32 m0, s88, 147456
    s_waitcnt lgkmcnt(0)
    buffer_load_dwordx4 v36, s[28:31], s94 offen offset:0 lds
    buffer_load_dwordx4 v37, s[28:31], s94 offen offset:1024 lds
    buffer_load_dwordx4 v38, s[28:31], s94 offen offset:2048 lds
    buffer_load_dwordx4 v39, s[28:31], s94 offen offset:3072 lds
    s_add_u32 s94, s94, 32768
L_join:
    s_waitcnt lgkmcnt(0)
    s_and_b64 s[52:53], s[52:53], s[54:55]
    s_and_b64 s[52:53], s[52:53], s[56:57]
    s_and_b64 s[52:53], s[52:53], s[58:59]
    s_and_b64 s[52:53], s[52:53], s[60:61]
    s_and_b64 s[52:53], s[52:53], s[62:63]
    s_and_b64 s[52:53], s[52:53], s[64:65]
    s_and_b32 s52, s52, s53
    s_cmp_eq_u32 s52, 1
    s_cbranch_scc0 L_pa_retry
L_pa_ok:
    buffer_load_dwordx4 v[128:131], v1, s[32:35], s93 offen offset:0 sc1
    ds_read_b64_tr_b16 a[112:113], v2 offset:0
    ds_read_b64_tr_b16 a[114:115], v2 offset:2048
    ds_read_b64_tr_b16 a[116:117], v3 offset:0
    ds_read_b64_tr_b16 a[118:119], v3 offset:2048
    buffer_load_dwordx4 v[132:135], v1, s[32:35], s93 offen offset:1024 sc1
    ds_read_b64_tr_b16 a[120:121], v4 offset:0
    ds_read_b64_tr_b16 a[122:123], v4 offset:2048
    ds_read_b64_tr_b16 a[124:125], v5 offset:0
    ds_read_b64_tr_b16 a[126:127], v5 offset:2048
    buffer_load_dwordx4 v[136:139], v1, s[32:35], s93 offen offset:2048 sc1
    ds_read_b64_tr_b16 a[128:129], v2 offset:16384
    ds_read_b64_tr_b16 a[130:131], v2 offset:18432
    ds_read_b64_tr_b16 a[132:133], v3 offset:16384
    ds_read_b64_tr_b16 a[134:135], v3 offset:18432
    buffer_load_dwordx4 v[140:143], v1, s[32:35], s93 offen offset:3072 sc1
    ds_read_b64_tr_b16 a[136:137], v4 offset:16384
    ds_read_b64_tr_b16 a[138:139], v4 offset:18432
    ds_read_b64_tr_b16 a[140:141], v5 offset:16384
    ds_read_b64_tr_b16 a[142:143], v5 offset:18432
    s_add_u32 s93, s93, 4096
    buffer_load_dwordx4 v[144:147], v1, s[32:35], s93 offen offset:0 sc1
    s_waitcnt vmcnt(22)
    ds_read_b64_tr_b16 a[144:145], v2 offset:32768
    ds_read_b64_tr_b16 a[146:147], v2 offset:34816
    ds_read_b64_tr_b16 a[148:149], v3 offset:32768
    ds_read_b64_tr_b16 a[150:151], v3 offset:34816
    buffer_load_dwordx4 v[148:151], v1, s[32:35], s93 offen offset:1024 sc1
    ds_read_b64_tr_b16 a[152:153], v4 offset:32768
    ds_read_b64_tr_b16 a[154:155], v4 offset:34816
    ds_read_b64_tr_b16 a[156:157], v5 offset:32768
    ds_read_b64_tr_b16 a[158:159], v5 offset:34816
    buffer_load_dwordx4 v[152:155], v1, s[32:35], s93 offen offset:2048 sc1
    s_waitcnt vmcnt(20)
    ds_read_b64_tr_b16 a[160:161], v6 offset:0
    ds_read_b64_tr_b16 a[162:163], v6 offset:2048
    ds_read_b64_tr_b16 a[164:165], v7 offset:0
    ds_read_b64_tr_b16 a[166:167], v7 offset:2048
    s_add_u32 s93, s93, s96
    buffer_load_dwordx4 v[156:159], v1, s[32:35], s93 offen offset:0 sc1
    ds_read_b64_tr_b16 a[168:169], v8 offset:0
    ds_read_b64_tr_b16 a[170:171], v8 offset:2048
    ds_read_b64_tr_b16 a[172:173], v9 offset:0
    ds_read_b64_tr_b16 a[174:175], v9 offset:2048
    buffer_load_dwordx4 v[160:163], v1, s[32:35], s93 offen offset:1024 sc1
    s_waitcnt vmcnt(18)
    ds_read_b64_tr_b16 a[176:177], v6 offset:16384
    ds_read_b64_tr_b16 a[178:179], v6 offset:18432
    ds_read_b64_tr_b16 a[180:181], v7 offset:16384
    ds_read_b64_tr_b16 a[182:183], v7 offset:18432
    buffer_load_dwordx4 v[164:167], v1, s[32:35], s93 offen offset:2048 sc1
    ds_read_b64_tr_b16 a[184:185], v8 offset:16384
    ds_read_b64_tr_b16 a[186:187], v8 offset:18432
    ds_read_b64_tr_b16 a[188:189], v9 offset:16384
    ds_read_b64_tr_b16 a[190:191], v9 offset:18432
    s_waitcnt vmcnt(14)
    ds_read_b64_tr_b16 a[192:193], v6 offset:32768
    ds_read_b64_tr_b16 a[194:195], v6 offset:34816
    ds_read_b64_tr_b16 a[196:197], v7 offset:32768
    ds_read_b64_tr_b16 a[198:199], v7 offset:34816
    ds_read_b64_tr_b16 a[200:201], v8 offset:32768
    ds_read_b64_tr_b16 a[202:203], v8 offset:34816
    ds_read_b64_tr_b16 a[204:205], v9 offset:32768
    ds_read_b64_tr_b16 a[206:207], v9 offset:34816
    s_waitcnt vmcnt(10)
    ds_read_b64_tr_b16 a[208:209], v2 offset:49152
    ds_read_b64_tr_b16 a[210:211], v2 offset:51200
    ds_read_b64_tr_b16 a[212:213], v3 offset:49152
    ds_read_b64_tr_b16 a[214:215], v3 offset:51200
    ds_read_b64_tr_b16 a[216:217], v4 offset:49152
    ds_read_b64_tr_b16 a[218:219], v4 offset:51200
    ds_read_b64_tr_b16 a[220:221], v5 offset:49152
    ds_read_b64_tr_b16 a[222:223], v5 offset:51200
    s_lshl_b32 s86, s84, 7
    v_and_b32 v15, 0x78, v60
    buffer_load_dwordx2 v[16:17], v15, s[48:51], s86 offen
    s_waitcnt lgkmcnt(0)
    s_waitcnt vmcnt(10)
    v_mfma_f32_16x16x32_bf16 v[64:67], a[0:3], v[128:131], 0
    v_mfma_f32_16x16x32_bf16 v[68:71], a[4:7], v[128:131], 0
    buffer_load_dwordx4 v[168:171], v1, s[32:35], s93 offen offset:3072 sc1
    v_mfma_f32_16x16x32_bf16 v[72:75], a[8:11], v[128:131], 0
    v_mfma_f32_16x16x32_bf16 v[76:79], a[12:15], v[128:131], 0
    s_waitcnt vmcnt(10)
    v_mfma_f32_16x16x32_bf16 v[64:67], a[16:19], v[132:135], v[64:67]
    v_mfma_f32_16x16x32_bf16 v[68:71], a[20:23], v[132:135], v[68:71]
    s_add_u32 s93, s93, 4096
    buffer_load_dwordx4 v[172:175], v1, s[32:35], s93 offen offset:0 sc1
    v_mfma_f32_16x16x32_bf16 v[72:75], a[24:27], v[132:135], v[72:75]
    v_mfma_f32_16x16x32_bf16 v[76:79], a[28:31], v[132:135], v[76:79]
    s_waitcnt vmcnt(10)
    v_mfma_f32_16x16x32_bf16 v[64:67], a[32:35], v[136:139], v[64:67]
    v_mfma_f32_16x16x32_bf16 v[68:71], a[36:39], v[136:139], v[68:71]
    buffer_load_dwordx4 v[176:179], v1, s[32:35], s93 offen offset:1024 sc1
    v_mfma_f32_16x16x32_bf16 v[72:75], a[40:43], v[136:139], v[72:75]
    v_mfma_f32_16x16x32_bf16 v[76:79], a[44:47], v[136:139], v[76:79]
    s_waitcnt vmcnt(10)
    v_mfma_f32_16x16x32_bf16 v[64:67], a[48:51], v[140:143], v[64:67]
    v_mfma_f32_16x16x32_bf16 v[68:71], a[52:55], v[140:143], v[68:71]
    buffer_load_dwordx4 v[180:183], v1, s[32:35], s93 offen offset:2048 sc1
    v_mfma_f32_16x16x32_bf16 v[72:75], a[56:59], v[140:143], v[72:75]
    v_mfma_f32_16x16x32_bf16 v[76:79], a[60:63], v[140:143], v[76:79]
    s_waitcnt vmcnt(10)
    v_mfma_f32_16x16x32_bf16 v[64:67], a[64:67], v[144:147], v[64:67]
    v_mfma_f32_16x16x32_bf16 v[68:71], a[68:71], v[144:147], v[68:71]
    s_add_u32 s93, s93, s97
    buffer_load_dwordx4 v[184:187], v1, s[32:35], s93 offen offset:0 sc1
    v_mfma_f32_16x16x32_bf16 v[72:75], a[72:75], v[144:147], v[72:75]
    v_mfma_f32_16x16x32_bf16 v[76:79], a[76:79], v[144:147], v[76:79]
    s_waitcnt vmcnt(10)
    v_mfma_f32_16x16x32_bf16 v[64:67], a[80:83], v[148:151], v[64:67]
    v_mfma_f32_16x16x32_bf16 v[68:71], a[84:87], v[148:151], v[68:71]
    buffer_load_dwordx4 v[188:191], v1, s[32:35], s93 offen offset:1024 sc1
    v_mfma_f32_16x16x32_bf16 v[72:75], a[88:91], v[148:151], v[72:75]
    v_mfma_f32_16x16x32_bf16 v[76:79], a[92:95], v[148:151], v[76:79]
    s_waitcnt vmcnt(10)
    v_mfma_f32_16x16x32_bf16 v[64:67], a[96:99], v[152:155], v[64:67]
    v_mfma_f32_16x16x32_bf16 v[68:71], a[100:103], v[152:155], v[68:71]
    buffer_load_dwordx4 v[192:195], v1, s[32:35], s93 offen offset:2048 sc1
    v_mfma_f32_16x16x32_bf16 v[72:75], a[104:107], v[152:155], v[72:75]
    v_mfma_f32_16x16x32_bf16 v[76:79], a[108:111], v[152:155], v[76:79]
    s_waitcnt vmcnt(10)
    v_mfma_f32_16x16x32_bf16 v[64:67], a[112:115], v[156:159], v[64:67]
    v_mfma_f32_16x16x32_bf16 v[68:71], a[116:119], v[156:159], v[68:71]
    buffer_load_dwordx4 v[196:199], v1, s[32:35], s93 offen offset:3072 sc1
    v_mfma_f32_16x16x32_bf16 v[72:75], a[120:123], v[156:159], v[72:75]
    v_mfma_f32_16x16x32_bf16 v[76:79], a[124:127], v[156:159], v[76:79]
    s_waitcnt vmcnt(10)
    v_mfma_f32_16x16x32_bf16 v[64:67], a[128:131], v[160:163], v[64:67]
    v_mfma_f32_16x16x32_bf16 v[68:71], a[132:135], v[160:163], v[68:71]
    s_add_u32 s93, s93, 4096
    buffer_load_dwordx4 v[200:203], v1, s[32:35], s93 offen offset:0 sc1
    v_mfma_f32_16x16x32_bf16 v[72:75], a[136:139], v[160:163], v[72:75]
    v_mfma_f32_16x16x32_bf16 v[76:79], a[140:143], v[160:163], v[76:79]
    s_waitcnt vmcnt(10)
    v_mfma_f32_16x16x32_bf16 v[64:67], a[144:147], v[164:167], v[64:67]
    v_mfma_f32_16x16x32_bf16 v[68:71], a[148:151], v[164:167], v[68:71]
    buffer_load_dwordx4 v[204:207], v1, s[32:35], s93 offen offset:1024 sc1
    v_mfma_f32_16x16x32_bf16 v[72:75], a[152:155], v[164:167], v[72:75]
    v_mfma_f32_16x16x32_bf16 v[76:79], a[156:159], v[164:167], v[76:79]
    s_waitcnt vmcnt(9)
    v_mfma_f32_16x16x32_bf16 v[64:67], a[160:163], v[168:171], v[64:67]
    v_mfma_f32_16x16x32_bf16 v[68:71], a[164:167], v[168:171], v[68:71]
    s_load_dwordx16 s[52:67], s[0:1], 512
    buffer_load_dwordx4 v[208:211], v1, s[32:35], s93 offen offset:2048 sc1
    v_mfma_f32_16x16x32_bf16 v[72:75], a[168:171], v[168:171], v[72:75]
    v_mfma_f32_16x16x32_bf16 v[76:79], a[172:175], v[168:171], v[76:79]
    s_waitcnt vmcnt(9)
    v_mfma_f32_16x16x32_bf16 v[64:67], a[176:179], v[172:175], v[64:67]
    v_mfma_f32_16x16x32_bf16 v[68:71], a[180:183], v[172:175], v[68:71]
    s_add_u32 s93, s93, s96
    buffer_load_dwordx4 v[212:215], v1, s[32:35], s93 offen offset:0 sc1
    v_mfma_f32_16x16x32_bf16 v[72:75], a[184:187], v[172:175], v[72:75]
    v_lshlrev_b32 v20, 16, v16
    v_and_b32 v21, 0xffff0000, v16
    v_mfma_f32_16x16x32_bf16 v[76:79], a[188:191], v[172:175], v[76:79]
    v_lshlrev_b32 v22, 16, v17
    v_and_b32 v23, 0xffff0000, v17
    s_waitcnt vmcnt(9)
    v_mfma_f32_16x16x32_bf16 v[64:67], a[192:195], v[176:179], v[64:67]
    v_mfma_f32_16x16x32_bf16 v[68:71], a[196:199], v[176:179], v[68:71]
    buffer_load_dwordx4 v[216:219], v1, s[32:35], s93 offen offset:1024 sc1
    v_mfma_f32_16x16x32_bf16 v[72:75], a[200:203], v[176:179], v[72:75]
    v_mfma_f32_16x16x32_bf16 v[76:79], a[204:207], v[176:179], v[76:79]
    s_waitcnt vmcnt(9)
    v_mfma_f32_16x16x32_bf16 v[64:67], a[208:211], v[180:183], v[64:67]
    v_mfma_f32_16x16x32_bf16 v[68:71], a[212:215], v[180:183], v[68:71]
    buffer_load_dwordx4 v[220:223], v1, s[32:35], s93 offen offset:2048 sc1
    v_mfma_f32_16x16x32_bf16 v[72:75], a[216:219], v[180:183], v[72:75]
    v_mfma_f32_16x16x32_bf16 v[76:79], a[220:223], v[180:183], v[76:79]
    s_waitcnt vmcnt(9)
    v_mfma_f32_16x16x32_bf16 v[80:83], a[0:3], v[184:187], 0
    v_mfma_f32_16x16x32_bf16 v[84:87], a[4:7], v[184:187], 0
    buffer_load_dwordx4 v[224:227], v1, s[32:35], s93 offen offset:3072 sc1
    v_mfma_f32_16x16x32_bf16 v[88:91], a[8:11], v[184:187], 0
    v_mfma_f32_16x16x32_bf16 v[92:95], a[12:15], v[184:187], 0
    s_waitcnt vmcnt(9)
    v_mfma_f32_16x16x32_bf16 v[80:83], a[16:19], v[188:191], v[80:83]
    ds_write_b128 v55, v[64:67] offset:0
    v_mfma_f32_16x16x32_bf16 v[84:87], a[20:23], v[188:191], v[84:87]
    s_add_u32 s93, s93, 4096
    buffer_load_dwordx4 v[228:231], v1, s[32:35], s93 offen offset:0 sc1
    v_mfma_f32_16x16x32_bf16 v[88:91], a[24:27], v[188:191], v[88:91]
    ds_write_b128 v56, v[68:71] offset:1024
    v_mfma_f32_16x16x32_bf16 v[92:95], a[28:31], v[188:191], v[92:95]
    ds_write_b128 v57, v[72:75] offset:2048
    s_waitcnt vmcnt(9)
    v_mfma_f32_16x16x32_bf16 v[80:83], a[32:35], v[192:195], v[80:83]
    ds_write_b128 v58, v[76:79] offset:3072
    v_mfma_f32_16x16x32_bf16 v[84:87], a[36:39], v[192:195], v[84:87]
    buffer_load_dwordx4 v[232:235], v1, s[32:35], s93 offen offset:1024 sc1
    v_mfma_f32_16x16x32_bf16 v[88:91], a[40:43], v[192:195], v[88:91]
    v_mfma_f32_16x16x32_bf16 v[92:95], a[44:47], v[192:195], v[92:95]
    s_waitcnt vmcnt(9)
    v_mfma_f32_16x16x32_bf16 v[80:83], a[48:51], v[196:199], v[80:83]
    v_mfma_f32_16x16x32_bf16 v[84:87], a[52:55], v[196:199], v[84:87]
    buffer_load_dwordx4 v[236:239], v1, s[32:35], s93 offen offset:2048 sc1
    v_mfma_f32_16x16x32_bf16 v[88:91], a[56:59], v[196:199], v[88:91]
    v_mfma_f32_16x16x32_bf16 v[92:95], a[60:63], v[196:199], v[92:95]
    s_waitcnt vmcnt(9)
    v_mfma_f32_16x16x32_bf16 v[80:83], a[64:67], v[200:203], v[80:83]
    s_waitcnt lgkmcnt(0)
    s_barrier
    v_mfma_f32_16x16x32_bf16 v[84:87], a[68:71], v[200:203], v[84:87]
    s_waitcnt lgkmcnt(0)
    s_and_b64 s[52:53], s[52:53], s[54:55]
    s_and_b64 s[52:53], s[52:53], s[56:57]
    s_and_b64 s[52:53], s[52:53], s[58:59]
    s_and_b64 s[52:53], s[52:53], s[60:61]
    s_and_b64 s[52:53], s[52:53], s[62:63]
    s_and_b64 s[52:53], s[52:53], s[64:65]
    s_and_b32 s52, s52, s53
    s_cmp_eq_u32 s52, 1
    s_cbranch_scc0 L_pb_retry
L_pb_ok:
    s_add_u32 s93, s93, s90
    buffer_load_dwordx4 v[240:243], v1, s[32:35], s93 offen offset:0 sc1
    v_mfma_f32_16x16x32_bf16 v[88:91], a[72:75], v[200:203], v[88:91]
    ds_read_b128 v[64:67], v59 offset:0
    v_mfma_f32_16x16x32_bf16 v[92:95], a[76:79], v[200:203], v[92:95]
    ds_read_b128 v[68:71], v59 offset:4096
    s_waitcnt vmcnt(9)
    v_mfma_f32_16x16x32_bf16 v[80:83], a[80:83], v[204:207], v[80:83]
    ds_read_b128 v[72:75], v59 offset:8192
    v_mfma_f32_16x16x32_bf16 v[84:87], a[84:87], v[204:207], v[84:87]
    buffer_load_dwordx4 v[244:247], v1, s[32:35], s93 offen offset:1024 sc1
    v_mfma_f32_16x16x32_bf16 v[88:91], a[88:91], v[204:207], v[88:91]
    ds_read_b128 v[76:79], v59 offset:12288
    v_mfma_f32_16x16x32_bf16 v[92:95], a[92:95], v[204:207], v[92:95]
    s_waitcnt vmcnt(9)
    v_mfma_f32_16x16x32_bf16 v[80:83], a[96:99], v[208:211], v[80:83]
    s_waitcnt lgkmcnt(2)
    v_mfma_f32_16x16x32_bf16 v[84:87], a[100:103], v[208:211], v[84:87]
    buffer_load_dwordx4 v[248:251], v1, s[32:35], s93 offen offset:2048 sc1
    v_mfma_f32_16x16x32_bf16 v[88:91], a[104:107], v[208:211], v[88:91]
    v_add_f32 v64, v64, v20
    v_mfma_f32_16x16x32_bf16 v[92:95], a[108:111], v[208:211], v[92:95]
    v_add_f32 v65, v65, v21
    s_waitcnt vmcnt(9)
    v_mfma_f32_16x16x32_bf16 v[80:83], a[112:115], v[212:215], v[80:83]
    v_add_f32 v66, v66, v22
    v_mfma_f32_16x16x32_bf16 v[84:87], a[116:119], v[212:215], v[84:87]
    buffer_load_dwordx4 v[252:255], v1, s[32:35], s93 offen offset:3072 sc1
    v_mfma_f32_16x16x32_bf16 v[88:91], a[120:123], v[212:215], v[88:91]
    v_add_f32 v67, v67, v23
    v_mfma_f32_16x16x32_bf16 v[92:95], a[124:127], v[212:215], v[92:95]
    v_add_f32 v64, v64, v68
    s_waitcnt vmcnt(9)
    v_mfma_f32_16x16x32_bf16 v[80:83], a[128:131], v[216:219], v[80:83]
    v_add_f32 v65, v65, v69
    v_mfma_f32_16x16x32_bf16 v[84:87], a[132:135], v[216:219], v[84:87]
    s_add_u32 s93, s93, 4096
    buffer_load_dwordx4 v[128:131], v1, s[32:35], s93 offen offset:0 sc1
    v_mfma_f32_16x16x32_bf16 v[88:91], a[136:139], v[216:219], v[88:91]
    v_add_f32 v66, v66, v70
    v_mfma_f32_16x16x32_bf16 v[92:95], a[140:143], v[216:219], v[92:95]
    v_add_f32 v67, v67, v71
    s_waitcnt vmcnt(9)
    v_mfma_f32_16x16x32_bf16 v[80:83], a[144:147], v[220:223], v[80:83]
    s_waitcnt lgkmcnt(0)
    v_mfma_f32_16x16x32_bf16 v[84:87], a[148:151], v[220:223], v[84:87]
    buffer_load_dwordx4 v[132:135], v1, s[32:35], s93 offen offset:1024 sc1
    v_mfma_f32_16x16x32_bf16 v[88:91], a[152:155], v[220:223], v[88:91]
    v_add_f32 v72, v72, v76
    v_mfma_f32_16x16x32_bf16 v[92:95], a[156:159], v[220:223], v[92:95]
    v_add_f32 v73, v73, v77
    s_waitcnt vmcnt(9)
    v_mfma_f32_16x16x32_bf16 v[80:83], a[160:163], v[224:227], v[80:83]
    v_add_f32 v74, v74, v78
    v_mfma_f32_16x16x32_bf16 v[84:87], a[164:167], v[224:227], v[84:87]
    buffer_load_dwordx4 v[136:139], v1, s[32:35], s93 offen offset:2048 sc1
    v_mfma_f32_16x16x32_bf16 v[88:91], a[168:171], v[224:227], v[88:91]
    v_add_f32 v75, v75, v79
    v_mfma_f32_16x16x32_bf16 v[92:95], a[172:175], v[224:227], v[92:95]
    v_add_f32 v64, v64, v72
    s_waitcnt vmcnt(9)
    v_mfma_f32_16x16x32_bf16 v[80:83], a[176:179], v[228:231], v[80:83]
    v_add_f32 v65, v65, v73
    v_mfma_f32_16x16x32_bf16 v[84:87], a[180:183], v[228:231], v[84:87]
    s_add_u32 s93, s93, s96
    buffer_load_dwordx4 v[140:143], v1, s[32:35], s93 offen offset:0 sc1
    v_mfma_f32_16x16x32_bf16 v[88:91], a[184:187], v[228:231], v[88:91]
    v_add_f32 v66, v66, v74
    v_mfma_f32_16x16x32_bf16 v[92:95], a[188:191], v[228:231], v[92:95]
    v_add_f32 v67, v67, v75
    s_waitcnt vmcnt(9)
    v_mfma_f32_16x16x32_bf16 v[80:83], a[192:195], v[232:235], v[80:83]
    v_cvt_pk_bf16_f32 v64, v64, v65
    v_mfma_f32_16x16x32_bf16 v[84:87], a[196:199], v[232:235], v[84:87]
    buffer_load_dwordx4 v[144:147], v1, s[32:35], s93 offen offset:1024 sc1
    v_mfma_f32_16x16x32_bf16 v[88:91], a[200:203], v[232:235], v[88:91]
    v_cvt_pk_bf16_f32 v65, v66, v67
    v_mfma_f32_16x16x32_bf16 v[92:95], a[204:207], v[232:235], v[92:95]
    buffer_store_dwordx2 v[64:65], v60, s[36:39], s68 offen
    s_waitcnt vmcnt(10)
    v_mfma_f32_16x16x32_bf16 v[80:83], a[208:211], v[236:239], v[80:83]
    v_mfma_f32_16x16x32_bf16 v[84:87], a[212:215], v[236:239], v[84:87]
    buffer_load_dwordx4 v[148:151], v1, s[32:35], s93 offen offset:2048 sc1
    v_mfma_f32_16x16x32_bf16 v[88:91], a[216:219], v[236:239], v[88:91]
    v_mfma_f32_16x16x32_bf16 v[92:95], a[220:223], v[236:239], v[92:95]
    s_waitcnt vmcnt(10)
    v_mfma_f32_16x16x32_bf16 v[96:99], a[0:3], v[240:243], 0
    v_mfma_f32_16x16x32_bf16 v[100:103], a[4:7], v[240:243], 0
    buffer_load_dwordx4 v[152:155], v1, s[32:35], s93 offen offset:3072 sc1
    v_mfma_f32_16x16x32_bf16 v[104:107], a[8:11], v[240:243], 0
    v_mfma_f32_16x16x32_bf16 v[108:111], a[12:15], v[240:243], 0
    s_waitcnt vmcnt(10)
    v_mfma_f32_16x16x32_bf16 v[96:99], a[16:19], v[244:247], v[96:99]
    ds_write_b128 v55, v[80:83] offset:16384
    v_mfma_f32_16x16x32_bf16 v[100:103], a[20:23], v[244:247], v[100:103]
    s_add_u32 s93, s93, 4096
    buffer_load_dwordx4 v[156:159], v1, s[32:35], s93 offen offset:0 sc1
    v_mfma_f32_16x16x32_bf16 v[104:107], a[24:27], v[244:247], v[104:107]
    ds_write_b128 v56, v[84:87] offset:17408
    v_mfma_f32_16x16x32_bf16 v[108:111], a[28:31], v[244:247], v[108:111]
    ds_write_b128 v57, v[88:91] offset:18432
    s_waitcnt vmcnt(10)
    v_mfma_f32_16x16x32_bf16 v[96:99], a[32:35], v[248:251], v[96:99]
    ds_write_b128 v58, v[92:95] offset:19456
    v_mfma_f32_16x16x32_bf16 v[100:103], a[36:39], v[248:251], v[100:103]
    buffer_load_dwordx4 v[160:163], v1, s[32:35], s93 offen offset:1024 sc1
    v_mfma_f32_16x16x32_bf16 v[104:107], a[40:43], v[248:251], v[104:107]
    v_mfma_f32_16x16x32_bf16 v[108:111], a[44:47], v[248:251], v[108:111]
    s_waitcnt vmcnt(10)
    v_mfma_f32_16x16x32_bf16 v[96:99], a[48:51], v[252:255], v[96:99]
    v_mfma_f32_16x16x32_bf16 v[100:103], a[52:55], v[252:255], v[100:103]
    buffer_load_dwordx4 v[164:167], v1, s[32:35], s93 offen offset:2048 sc1
    v_mfma_f32_16x16x32_bf16 v[104:107], a[56:59], v[252:255], v[104:107]
    v_mfma_f32_16x16x32_bf16 v[108:111], a[60:63], v[252:255], v[108:111]
    s_waitcnt vmcnt(10)
    v_mfma_f32_16x16x32_bf16 v[96:99], a[64:67], v[128:131], v[96:99]
    s_waitcnt lgkmcnt(0)
    s_barrier
    v_mfma_f32_16x16x32_bf16 v[100:103], a[68:71], v[128:131], v[100:103]
    s_add_u32 s93, s93, s97
    buffer_load_dwordx4 v[168:171], v1, s[32:35], s93 offen offset:0 sc1
    v_mfma_f32_16x16x32_bf16 v[104:107], a[72:75], v[128:131], v[104:107]
    ds_read_b128 v[80:83], v59 offset:16384
    v_mfma_f32_16x16x32_bf16 v[108:111], a[76:79], v[128:131], v[108:111]
    ds_read_b128 v[84:87], v59 offset:20480
    s_waitcnt vmcnt(10)
    v_mfma_f32_16x16x32_bf16 v[96:99], a[80:83], v[132:135], v[96:99]
    ds_read_b128 v[88:91], v59 offset:24576
    v_mfma_f32_16x16x32_bf16 v[100:103], a[84:87], v[132:135], v[100:103]
    buffer_load_dwordx4 v[172:175], v1, s[32:35], s93 offen offset:1024 sc1
    v_mfma_f32_16x16x32_bf16 v[104:107], a[88:91], v[132:135], v[104:107]
    ds_read_b128 v[92:95], v59 offset:28672
    v_mfma_f32_16x16x32_bf16 v[108:111], a[92:95], v[132:135], v[108:111]
    s_waitcnt vmcnt(10)
    v_mfma_f32_16x16x32_bf16 v[96:99], a[96:99], v[136:139], v[96:99]
    s_waitcnt lgkmcnt(2)
    v_mfma_f32_16x16x32_bf16 v[100:103], a[100:103], v[136:139], v[100:103]
    buffer_load_dwordx4 v[176:179], v1, s[32:35], s93 offen offset:2048 sc1
    v_mfma_f32_16x16x32_bf16 v[104:107], a[104:107], v[136:139], v[104:107]
    v_add_f32 v80, v80, v20
    v_mfma_f32_16x16x32_bf16 v[108:111], a[108:111], v[136:139], v[108:111]
    v_add_f32 v81, v81, v21
    s_waitcnt vmcnt(10)
    v_mfma_f32_16x16x32_bf16 v[96:99], a[112:115], v[140:143], v[96:99]
    v_add_f32 v82, v82, v22
    v_mfma_f32_16x16x32_bf16 v[100:103], a[116:119], v[140:143], v[100:103]
    buffer_load_dwordx4 v[180:183], v1, s[32:35], s93 offen offset:3072 sc1
    v_mfma_f32_16x16x32_bf16 v[104:107], a[120:123], v[140:143], v[104:107]
    v_add_f32 v83, v83, v23
    v_mfma_f32_16x16x32_bf16 v[108:111], a[124:127], v[140:143], v[108:111]
    v_add_f32 v80, v80, v84
    s_waitcnt vmcnt(10)
    v_mfma_f32_16x16x32_bf16 v[96:99], a[128:131], v[144:147], v[96:99]
    v_add_f32 v81, v81, v85
    v_mfma_f32_16x16x32_bf16 v[100:103], a[132:135], v[144:147], v[100:103]
    s_add_u32 s93, s93, 4096
    buffer_load_dwordx4 v[184:187], v1, s[32:35], s93 offen offset:0 sc1
    v_mfma_f32_16x16x32_bf16 v[104:107], a[136:139], v[144:147], v[104:107]
    v_add_f32 v82, v82, v86
    v_mfma_f32_16x16x32_bf16 v[108:111], a[140:143], v[144:147], v[108:111]
    v_add_f32 v83, v83, v87
    s_waitcnt vmcnt(9)
    v_mfma_f32_16x16x32_bf16 v[96:99], a[144:147], v[148:151], v[96:99]
    s_waitcnt lgkmcnt(0)
    v_mfma_f32_16x16x32_bf16 v[100:103], a[148:151], v[148:151], v[100:103]
    buffer_load_dwordx4 v[188:191], v1, s[32:35], s93 offen offset:1024 sc1
    v_mfma_f32_16x16x32_bf16 v[104:107], a[152:155], v[148:151], v[104:107]
    v_add_f32 v88, v88, v92
    v_mfma_f32_16x16x32_bf16 v[108:111], a[156:159], v[148:151], v[108:111]
    v_add_f32 v89, v89, v93
    s_waitcnt vmcnt(9)
    v_mfma_f32_16x16x32_bf16 v[96:99], a[160:163], v[152:155], v[96:99]
    v_add_f32 v90, v90, v94
    v_mfma_f32_16x16x32_bf16 v[100:103], a[164:167], v[152:155], v[100:103]
    buffer_load_dwordx4 v[192:195], v1, s[32:35], s93 offen offset:2048 sc1
    v_mfma_f32_16x16x32_bf16 v[104:107], a[168:171], v[152:155], v[104:107]
    v_add_f32 v91, v91, v95
    v_mfma_f32_16x16x32_bf16 v[108:111], a[172:175], v[152:155], v[108:111]
    v_add_f32 v80, v80, v88
    s_waitcnt vmcnt(9)
    v_mfma_f32_16x16x32_bf16 v[96:99], a[176:179], v[156:159], v[96:99]
    v_add_f32 v81, v81, v89
    v_mfma_f32_16x16x32_bf16 v[100:103], a[180:183], v[156:159], v[100:103]
    s_add_u32 s93, s93, s96
    buffer_load_dwordx4 v[196:199], v1, s[32:35], s93 offen offset:0 sc1
    v_mfma_f32_16x16x32_bf16 v[104:107], a[184:187], v[156:159], v[104:107]
    v_add_f32 v82, v82, v90
    v_mfma_f32_16x16x32_bf16 v[108:111], a[188:191], v[156:159], v[108:111]
    v_add_f32 v83, v83, v91
    s_waitcnt vmcnt(9)
    v_mfma_f32_16x16x32_bf16 v[96:99], a[192:195], v[160:163], v[96:99]
    v_cvt_pk_bf16_f32 v80, v80, v81
    v_mfma_f32_16x16x32_bf16 v[100:103], a[196:199], v[160:163], v[100:103]
    buffer_load_dwordx4 v[200:203], v1, s[32:35], s93 offen offset:1024 sc1
    v_mfma_f32_16x16x32_bf16 v[104:107], a[200:203], v[160:163], v[104:107]
    v_cvt_pk_bf16_f32 v81, v82, v83
    v_mfma_f32_16x16x32_bf16 v[108:111], a[204:207], v[160:163], v[108:111]
    s_add_u32 s68, s68, 16384
    buffer_store_dwordx2 v[80:81], v60, s[36:39], s68 offen
    s_waitcnt vmcnt(10)
    v_mfma_f32_16x16x32_bf16 v[96:99], a[208:211], v[164:167], v[96:99]
    v_mfma_f32_16x16x32_bf16 v[100:103], a[212:215], v[164:167], v[100:103]
    buffer_load_dwordx4 v[204:207], v1, s[32:35], s93 offen offset:2048 sc1
    v_mfma_f32_16x16x32_bf16 v[104:107], a[216:219], v[164:167], v[104:107]
    v_mfma_f32_16x16x32_bf16 v[108:111], a[220:223], v[164:167], v[108:111]
    s_waitcnt vmcnt(10)
    v_mfma_f32_16x16x32_bf16 v[112:115], a[0:3], v[168:171], 0
    v_mfma_f32_16x16x32_bf16 v[116:119], a[4:7], v[168:171], 0
    buffer_load_dwordx4 v[208:211], v1, s[32:35], s93 offen offset:3072 sc1
    v_mfma_f32_16x16x32_bf16 v[120:123], a[8:11], v[168:171], 0
    v_mfma_f32_16x16x32_bf16 v[124:127], a[12:15], v[168:171], 0
    s_waitcnt vmcnt(10)
    v_mfma_f32_16x16x32_bf16 v[112:115], a[16:19], v[172:175], v[112:115]
    ds_write_b128 v55, v[96:99] offset:32768
    v_mfma_f32_16x16x32_bf16 v[116:119], a[20:23], v[172:175], v[116:119]
    s_add_u32 s93, s93, 4096
    buffer_load_dwordx4 v[212:215], v1, s[32:35], s93 offen offset:0 sc1
    v_mfma_f32_16x16x32_bf16 v[120:123], a[24:27], v[172:175], v[120:123]
    ds_write_b128 v56, v[100:103] offset:33792
    v_mfma_f32_16x16x32_bf16 v[124:127], a[28:31], v[172:175], v[124:127]
    ds_write_b128 v57, v[104:107] offset:34816
    s_waitcnt vmcnt(10)
    v_mfma_f32_16x16x32_bf16 v[112:115], a[32:35], v[176:179], v[112:115]
    ds_write_b128 v58, v[108:111] offset:35840
    v_mfma_f32_16x16x32_bf16 v[116:119], a[36:39], v[176:179], v[116:119]
    buffer_load_dwordx4 v[216:219], v1, s[32:35], s93 offen offset:1024 sc1
    v_mfma_f32_16x16x32_bf16 v[120:123], a[40:43], v[176:179], v[120:123]
    v_mfma_f32_16x16x32_bf16 v[124:127], a[44:47], v[176:179], v[124:127]
    s_waitcnt vmcnt(10)
    v_mfma_f32_16x16x32_bf16 v[112:115], a[48:51], v[180:183], v[112:115]
    v_mfma_f32_16x16x32_bf16 v[116:119], a[52:55], v[180:183], v[116:119]
    buffer_load_dwordx4 v[220:223], v1, s[32:35], s93 offen offset:2048 sc1
    v_mfma_f32_16x16x32_bf16 v[120:123], a[56:59], v[180:183], v[120:123]
    v_mfma_f32_16x16x32_bf16 v[124:127], a[60:63], v[180:183], v[124:127]
    s_waitcnt vmcnt(10)
    v_mfma_f32_16x16x32_bf16 v[112:115], a[64:67], v[184:187], v[112:115]
    s_waitcnt lgkmcnt(0)
    s_barrier
    v_mfma_f32_16x16x32_bf16 v[116:119], a[68:71], v[184:187], v[116:119]
    v_mfma_f32_16x16x32_bf16 v[120:123], a[72:75], v[184:187], v[120:123]
    ds_read_b128 v[96:99], v59 offset:32768
    v_mfma_f32_16x16x32_bf16 v[124:127], a[76:79], v[184:187], v[124:127]
    ds_read_b128 v[100:103], v59 offset:36864
    s_waitcnt vmcnt(9)
    v_mfma_f32_16x16x32_bf16 v[112:115], a[80:83], v[188:191], v[112:115]
    ds_read_b128 v[104:107], v59 offset:40960
    v_mfma_f32_16x16x32_bf16 v[116:119], a[84:87], v[188:191], v[116:119]
    v_mfma_f32_16x16x32_bf16 v[120:123], a[88:91], v[188:191], v[120:123]
    ds_read_b128 v[108:111], v59 offset:45056
    v_mfma_f32_16x16x32_bf16 v[124:127], a[92:95], v[188:191], v[124:127]
    s_waitcnt vmcnt(8)
    v_mfma_f32_16x16x32_bf16 v[112:115], a[96:99], v[192:195], v[112:115]
    s_waitcnt lgkmcnt(2)
    v_mfma_f32_16x16x32_bf16 v[116:119], a[100:103], v[192:195], v[116:119]
    v_mfma_f32_16x16x32_bf16 v[120:123], a[104:107], v[192:195], v[120:123]
    v_add_f32 v96, v96, v20
    v_mfma_f32_16x16x32_bf16 v[124:127], a[108:111], v[192:195], v[124:127]
    v_add_f32 v97, v97, v21
    s_waitcnt vmcnt(7)
    v_mfma_f32_16x16x32_bf16 v[112:115], a[112:115], v[196:199], v[112:115]
    v_add_f32 v98, v98, v22
    v_mfma_f32_16x16x32_bf16 v[116:119], a[116:119], v[196:199], v[116:119]
    v_mfma_f32_16x16x32_bf16 v[120:123], a[120:123], v[196:199], v[120:123]
    v_add_f32 v99, v99, v23
    v_mfma_f32_16x16x32_bf16 v[124:127], a[124:127], v[196:199], v[124:127]
    v_add_f32 v96, v96, v100
    s_waitcnt vmcnt(6)
    v_mfma_f32_16x16x32_bf16 v[112:115], a[128:131], v[200:203], v[112:115]
    v_add_f32 v97, v97, v101
    v_mfma_f32_16x16x32_bf16 v[116:119], a[132:135], v[200:203], v[116:119]
    v_mfma_f32_16x16x32_bf16 v[120:123], a[136:139], v[200:203], v[120:123]
    v_add_f32 v98, v98, v102
    v_mfma_f32_16x16x32_bf16 v[124:127], a[140:143], v[200:203], v[124:127]
    v_add_f32 v99, v99, v103
    s_waitcnt vmcnt(4)
    v_mfma_f32_16x16x32_bf16 v[112:115], a[144:147], v[204:207], v[112:115]
    s_waitcnt lgkmcnt(0)
    v_mfma_f32_16x16x32_bf16 v[116:119], a[148:151], v[204:207], v[116:119]
    v_mfma_f32_16x16x32_bf16 v[120:123], a[152:155], v[204:207], v[120:123]
    v_add_f32 v104, v104, v108
    v_mfma_f32_16x16x32_bf16 v[124:127], a[156:159], v[204:207], v[124:127]
    v_add_f32 v105, v105, v109
    s_waitcnt vmcnt(3)
    v_mfma_f32_16x16x32_bf16 v[112:115], a[160:163], v[208:211], v[112:115]
    v_add_f32 v106, v106, v110
    v_mfma_f32_16x16x32_bf16 v[116:119], a[164:167], v[208:211], v[116:119]
    v_mfma_f32_16x16x32_bf16 v[120:123], a[168:171], v[208:211], v[120:123]
    v_add_f32 v107, v107, v111
    v_mfma_f32_16x16x32_bf16 v[124:127], a[172:175], v[208:211], v[124:127]
    v_add_f32 v96, v96, v104
    s_waitcnt vmcnt(2)
    v_mfma_f32_16x16x32_bf16 v[112:115], a[176:179], v[212:215], v[112:115]
    v_add_f32 v97, v97, v105
    v_mfma_f32_16x16x32_bf16 v[116:119], a[180:183], v[212:215], v[116:119]
    v_mfma_f32_16x16x32_bf16 v[120:123], a[184:187], v[212:215], v[120:123]
    v_add_f32 v98, v98, v106
    v_mfma_f32_16x16x32_bf16 v[124:127], a[188:191], v[212:215], v[124:127]
    v_add_f32 v99, v99, v107
    s_waitcnt vmcnt(1)
    v_mfma_f32_16x16x32_bf16 v[112:115], a[192:195], v[216:219], v[112:115]
    v_cvt_pk_bf16_f32 v96, v96, v97
    v_mfma_f32_16x16x32_bf16 v[116:119], a[196:199], v[216:219], v[116:119]
    v_mfma_f32_16x16x32_bf16 v[120:123], a[200:203], v[216:219], v[120:123]
    v_cvt_pk_bf16_f32 v97, v98, v99
    v_mfma_f32_16x16x32_bf16 v[124:127], a[204:207], v[216:219], v[124:127]
    s_add_u32 s68, s68, 49152
    buffer_store_dwordx2 v[96:97], v60, s[36:39], s68 offen
    s_waitcnt vmcnt(1)
    v_mfma_f32_16x16x32_bf16 v[112:115], a[208:211], v[220:223], v[112:115]
    v_mfma_f32_16x16x32_bf16 v[116:119], a[212:215], v[220:223], v[116:119]
    v_mfma_f32_16x16x32_bf16 v[120:123], a[216:219], v[220:223], v[120:123]
    v_mfma_f32_16x16x32_bf16 v[124:127], a[220:223], v[220:223], v[124:127]
    s_nop 8
    ds_write_b128 v55, v[112:115] offset:49152
    ds_write_b128 v56, v[116:119] offset:50176
    ds_write_b128 v57, v[120:123] offset:51200
    ds_write_b128 v58, v[124:127] offset:52224
    s_waitcnt lgkmcnt(0)
    s_barrier
    ds_read_b128 v[112:115], v59 offset:49152
    ds_read_b128 v[116:119], v59 offset:53248
    ds_read_b128 v[120:123], v59 offset:57344
    ds_read_b128 v[124:127], v59 offset:61440
    s_waitcnt lgkmcnt(2)
    v_add_f32 v112, v112, v20
    v_add_f32 v113, v113, v21
    v_add_f32 v114, v114, v22
    v_add_f32 v115, v115, v23
    v_add_f32 v112, v112, v116
    v_add_f32 v113, v113, v117
    v_add_f32 v114, v114, v118
    v_add_f32 v115, v115, v119
    s_waitcnt lgkmcnt(0)
    v_add_f32 v120, v120, v124
    v_add_f32 v121, v121, v125
    v_add_f32 v122, v122, v126
    v_add_f32 v123, v123, v127
    v_add_f32 v112, v112, v120
    v_add_f32 v113, v113, v121
    v_add_f32 v114, v114, v122
    v_add_f32 v115, v115, v123
    v_cvt_pk_bf16_f32 v112, v112, v113
    v_cvt_pk_bf16_f32 v113, v114, v115
    s_add_u32 s68, s68, 16384
    buffer_store_dwordx2 v[112:113], v60, s[36:39], s68 offen
L_end_standalone__dense_activation_squared_relu__prompt_kernel:
    s_endpgm
L_spare0:
    s_mov_b64 s[28:29], s[10:11]
    s_mov_b32 s30, 1835008
    s_mov_b32 s31, 0x20000
    s_mov_b64 s[32:33], s[18:19]
    s_mov_b32 s34, 8404992
    s_mov_b32 s35, 0x20000
    s_mov_b64 s[48:49], s[12:13]
    s_mov_b32 s50, 1024
    s_mov_b32 s51, 0x20000
    s_mov_b64 s[36:37], s[14:15]
    s_mov_b32 s38, 2097152
    s_mov_b32 s39, 0x20000
    s_mov_b64 s[40:41], s[16:17]
    s_mov_b32 s42, 64
    s_mov_b32 s43, 0x20000
    s_and_b32 s85, s78, 28
    s_lshr_b32 s84, 929382928, s85
    s_and_b32 s84, s84, 7
    s_and_b32 s83, s78, 1
    s_bfe_u32 s82, s78, 0x10001
    s_lshl1_add_u32 s82, s79, s82
    s_xor_b32 s91, s83, s84
    v_lshlrev_b32 v1, 4, v0
    s_sub_u32 s85, s78, 28
    s_lshl1_add_u32 s86, s3, s85
    s_cmp_ge_u32 s86, 2
    s_cbranch_scc1 L_spare1
    s_lshl1_add_u32 s86, s79, s85
    s_lshl_b32 s87, s86, 10
    s_add_u32 s87, s87, 8388608
    v_mov_b32 v32, 0
    v_mov_b32 v33, 0
    v_mov_b32 v34, 0
    v_mov_b32 v35, 0
    buffer_store_dwordx4 v[32:35], v1, s[32:35], s87 offen sc1
    s_lshl_b32 s86, s86, 2
    v_mov_b32 v15, 0x7ff00000
    v_mov_b32 v61, 1
    v_writelane_b32 v15, s86, 0
    s_waitcnt vmcnt(0)
    buffer_store_dword v61, v15, s[40:43], 0 offen sc1
L_spare1:
    s_getpc_b64 s[76:77]
L_pc:
    s_sub_u32 s76, s76, L_pc-standalone__dense_activation_squared_relu__prompt_kernel
    s_subb_u32 s77, s77, 0
    s_lshl_b32 s85, s3, 12
    v_lshlrev_b32 v15, 6, v0
    v_add_u32 v15, s85, v15
    v_min_u32 v15, L_spare0-standalone__dense_activation_squared_relu__prompt_kernel, v15
    global_load_dword v49, v15, s[76:77]
    s_sub_u32 s85, s78, 28
    s_lshl3_add_u32 s85, s85, s79
    s_lshl2_add_u32 s85, s85, s3
    s_lshr_b32 s86, s85, 3
    s_lshl_b32 s86, s86, 17
    s_and_b32 s87, s85, 7
    s_lshl_b32 s87, s87, 13
    s_add_u32 s86, s86, s87
    v_lshlrev_b32 v15, 7, v0
    buffer_load_dword v49, v15, s[20:23], s86 offen
    s_add_u32 s86, s86, 65536
    s_waitcnt vmcnt(0)
    buffer_load_dword v49, v15, s[20:23], s86 offen
    s_mul_i32 s86, s85, 14336
    buffer_load_dword v49, v15, s[28:31], s86 offen
    s_add_u32 s86, s86, 8192
    s_mov_b32 exec_hi, 0xffff
    buffer_load_dword v49, v15, s[28:31], s86 offen
    s_mov_b32 exec_hi, -1
    s_lshl2_add_u32 s85, s82, s83
    s_mul_i32 s93, s85, 114688
    s_mul_i32 s86, s3, 14336
    s_add_u32 s93, s93, s86
    s_lshl3_add_u32 s85, s85, s3
    s_lshl_b32 s68, s85, 12
    s_lshl_b32 s87, s84, 7
    s_add_u32 s68, s68, s87
    v_lshrrev_b32 v15, 3, v0
    v_lshlrev_b32 v15, 10, v15
    v_lshlrev_b32 v63, 1, v62
    v_xor_b32 v63, v63, v0
    v_and_b32 v63, 7, v63
    v_lshl_add_u32 v36, v63, 4, v15
    v_add_u32 v37, 7168, v36
    v_add_u32 v38, 14336, v36
    v_add_u32 v39, 21504, v36
    s_mul_i32 s94, s3, 458752
    s_add_u32 s94, s94, s87
    s_and_b32 s85, s91, 1
    s_mul_i32 s86, s85, 229376
    s_add_u32 s94, s94, s86
    s_lshl_b32 s86, s86, 1
    s_sub_u32 s95, 32768, s86
    s_mul_i32 s86, s85, 7168
    s_add_u32 s93, s93, s86
    s_lshl_b32 s86, s86, 1
    s_sub_u32 s96, 3072, s86
    s_add_u32 s97, s86, 46080
    s_add_u32 s90, s86, 160768
    v_and_b32 v63, 15, v0
    v_lshlrev_b32 v60, 3, v63
    v_lshl_or_b32 v60, v62, 10, v60
    s_lshl_b32 s86, s3, 2
    v_add_u32 v15, s86, v62
    v_xor_b32 v15, v15, v63
    v_lshlrev_b32 v15, 4, v15
    v_lshl_or_b32 v59, v63, 8, v15
    v_add_u32 v59, 98304, v59
    v_xor_b32 v15, v63, v62
    v_lshlrev_b32 v15, 4, v15
    v_lshl_or_b32 v15, v62, 8, v15
    s_add_u32 s86, s88, 98304
    v_add_u32 v55, s86, v15
    v_xor_b32 v56, 64, v55
    v_xor_b32 v57, 128, v55
    v_xor_b32 v58, 192, v55
    v_bfe_u32 v63, v0, 2, 2
    v_lshl_add_u32 v15, v62, 2, v63
    v_lshlrev_b32 v15, 7, v15
    v_bfe_u32 v63, v0, 3, 2
    v_lshl_or_b32 v15, v63, 5, v15
    v_and_b32 v63, 3, v0
    v_lshl_or_b32 v48, v63, 3, v15
    s_lshl3_add_u32 s85, s82, s3
    s_lshl_b32 s85, s85, 7
    s_add_u32 s85, s85, 8388608
    s_add_u32 s0, s32, s85
    s_addc_u32 s1, s33, 0
    v_lshlrev_b32 v54, 2, v0
    v_add_u32 v51, s85, v54
    v_mov_b32 v61, 1
    v_mov_b32 v15, 0x7ff00000
    v_cmp_gt_u32 vcc, 14, v0
    s_nop 1
    v_cndmask_b32 v51, v15, v51, vcc
    v_cndmask_b32 v52, 0, v61, vcc
    v_cmp_gt_u32 vcc, 16, v0
    s_nop 1
    v_cndmask_b32 v53, 0, v61, vcc
    v_add_u32 v6, s88, v48
    v_xor_b32 v7, 32, v6
    v_xor_b32 v8, 64, v6
    v_xor_b32 v9, 96, v6
    v_add_u32 v2, 98304, v6
    v_add_u32 v3, 98304, v7
    v_add_u32 v4, 98304, v8
    v_add_u32 v5, 98304, v9
    s_add_u32 m0, s88, 98304
    s_nop 0
    buffer_load_dwordx4 v36, s[28:31], s94 offen offset:0 lds
    buffer_load_dwordx4 v37, s[28:31], s94 offen offset:1024 lds
    buffer_load_dwordx4 v38, s[28:31], s94 offen offset:2048 lds
    buffer_load_dwordx4 v39, s[28:31], s94 offen offset:3072 lds
    s_add_u32 s94, s94, 32768
    s_add_u32 m0, s88, 114688
    s_nop 0
    buffer_load_dwordx4 v36, s[28:31], s94 offen offset:0 lds
    buffer_load_dwordx4 v37, s[28:31], s94 offen offset:1024 lds
    buffer_load_dwordx4 v38, s[28:31], s94 offen offset:2048 lds
    buffer_load_dwordx4 v39, s[28:31], s94 offen offset:3072 lds
    s_add_u32 s94, s94, 32768
    s_add_u32 m0, s88, 131072
    s_nop 0
    buffer_load_dwordx4 v36, s[28:31], s94 offen offset:0 lds
    buffer_load_dwordx4 v37, s[28:31], s94 offen offset:1024 lds
    buffer_load_dwordx4 v38, s[28:31], s94 offen offset:2048 lds
    buffer_load_dwordx4 v39, s[28:31], s94 offen offset:3072 lds
    s_add_u32 s94, s94, 32768
    s_add_u32 m0, s88, 0
    s_nop 0
    buffer_load_dwordx4 v36, s[28:31], s94 offen offset:0 lds
    buffer_load_dwordx4 v37, s[28:31], s94 offen offset:1024 lds
    buffer_load_dwordx4 v38, s[28:31], s94 offen offset:2048 lds
    buffer_load_dwordx4 v39, s[28:31], s94 offen offset:3072 lds
    s_add_u32 s94, s94, 32768
    s_add_u32 m0, s88, 16384
    s_nop 0
    buffer_load_dwordx4 v36, s[28:31], s94 offen offset:0 lds
    buffer_load_dwordx4 v37, s[28:31], s94 offen offset:1024 lds
    buffer_load_dwordx4 v38, s[28:31], s94 offen offset:2048 lds
    buffer_load_dwordx4 v39, s[28:31], s94 offen offset:3072 lds
    s_add_u32 s94, s94, 32768
    s_add_u32 m0, s88, 32768
    s_nop 0
    buffer_load_dwordx4 v36, s[28:31], s94 offen offset:0 lds
    buffer_load_dwordx4 v37, s[28:31], s94 offen offset:1024 lds
    buffer_load_dwordx4 v38, s[28:31], s94 offen offset:2048 lds
    buffer_load_dwordx4 v39, s[28:31], s94 offen offset:3072 lds
    s_add_u32 s94, s94, 32768
    s_add_u32 m0, s88, 147456
    s_nop 0
    buffer_load_dwordx4 v36, s[28:31], s94 offen offset:0 lds
    buffer_load_dwordx4 v37, s[28:31], s94 offen offset:1024 lds
    buffer_load_dwordx4 v38, s[28:31], s94 offen offset:2048 lds
    buffer_load_dwordx4 v39, s[28:31], s94 offen offset:3072 lds
    s_add_u32 s94, s94, s95
    s_add_u32 m0, s88, 98304
    s_waitcnt vmcnt(24)
    ds_read_b64_tr_b16 a[0:1], v2 offset:0
    ds_read_b64_tr_b16 a[2:3], v2 offset:2048
    ds_read_b64_tr_b16 a[4:5], v3 offset:0
    ds_read_b64_tr_b16 a[6:7], v3 offset:2048
    ds_read_b64_tr_b16 a[8:9], v4 offset:0
    ds_read_b64_tr_b16 a[10:11], v4 offset:2048
    ds_read_b64_tr_b16 a[12:13], v5 offset:0
    ds_read_b64_tr_b16 a[14:15], v5 offset:2048
    s_waitcnt vmcnt(20)
    ds_read_b64_tr_b16 a[16:17], v2 offset:16384
    ds_read_b64_tr_b16 a[18:19], v2 offset:18432
    ds_read_b64_tr_b16 a[20:21], v3 offset:16384
    ds_read_b64_tr_b16 a[22:23], v3 offset:18432
    ds_read_b64_tr_b16 a[24:25], v4 offset:16384
    ds_read_b64_tr_b16 a[26:27], v4 offset:18432
    ds_read_b64_tr_b16 a[28:29], v5 offset:16384
    ds_read_b64_tr_b16 a[30:31], v5 offset:18432
    s_waitcnt lgkmcnt(8)
    buffer_load_dwordx4 v36, s[28:31], s94 offen offset:0 lds
    buffer_load_dwordx4 v37, s[28:31], s94 offen offset:1024 lds
    buffer_load_dwordx4 v38, s[28:31], s94 offen offset:2048 lds
    buffer_load_dwordx4 v39, s[28:31], s94 offen offset:3072 lds
    s_add_u32 s94, s94, 32768
    s_add_u32 m0, s88, 114688
    s_waitcnt vmcnt(20)
    ds_read_b64_tr_b16 a[32:33], v2 offset:32768
    ds_read_b64_tr_b16 a[34:35], v2 offset:34816
    ds_read_b64_tr_b16 a[36:37], v3 offset:32768
    ds_read_b64_tr_b16 a[38:39], v3 offset:34816
    ds_read_b64_tr_b16 a[40:41], v4 offset:32768
    ds_read_b64_tr_b16 a[42:43], v4 offset:34816
    ds_read_b64_tr_b16 a[44:45], v5 offset:32768
    ds_read_b64_tr_b16 a[46:47], v5 offset:34816
    s_waitcnt lgkmcnt(8)
    buffer_load_dwordx4 v36, s[28:31], s94 offen offset:0 lds
    buffer_load_dwordx4 v37, s[28:31], s94 offen offset:1024 lds
    buffer_load_dwordx4 v38, s[28:31], s94 offen offset:2048 lds
    buffer_load_dwordx4 v39, s[28:31], s94 offen offset:3072 lds
    s_add_u32 s94, s94, 32768
    s_add_u32 m0, s88, 131072
    s_waitcnt vmcnt(20)
    ds_read_b64_tr_b16 a[48:49], v6 offset:0
    ds_read_b64_tr_b16 a[50:51], v6 offset:2048
    ds_read_b64_tr_b16 a[52:53], v7 offset:0
    ds_read_b64_tr_b16 a[54:55], v7 offset:2048
    ds_read_b64_tr_b16 a[56:57], v8 offset:0
    ds_read_b64_tr_b16 a[58:59], v8 offset:2048
    ds_read_b64_tr_b16 a[60:61], v9 offset:0
    ds_read_b64_tr_b16 a[62:63], v9 offset:2048
    s_waitcnt lgkmcnt(8)
    buffer_load_dwordx4 v36, s[28:31], s94 offen offset:0 lds
    buffer_load_dwordx4 v37, s[28:31], s94 offen offset:1024 lds
    buffer_load_dwordx4 v38, s[28:31], s94 offen offset:2048 lds
    buffer_load_dwordx4 v39, s[28:31], s94 offen offset:3072 lds
    s_add_u32 s94, s94, 32768
    s_add_u32 m0, s88, 0
    s_waitcnt vmcnt(20)
    ds_read_b64_tr_b16 a[64:65], v6 offset:16384
    ds_read_b64_tr_b16 a[66:67], v6 offset:18432
    ds_read_b64_tr_b16 a[68:69], v7 offset:16384
    ds_read_b64_tr_b16 a[70:71], v7 offset:18432
    ds_read_b64_tr_b16 a[72:73], v8 offset:16384
    ds_read_b64_tr_b16 a[74:75], v8 offset:18432
    ds_read_b64_tr_b16 a[76:77], v9 offset:16384
    ds_read_b64_tr_b16 a[78:79], v9 offset:18432
    s_waitcnt lgkmcnt(8)
    buffer_load_dwordx4 v36, s[28:31], s94 offen offset:0 lds
    buffer_load_dwordx4 v37, s[28:31], s94 offen offset:1024 lds
    buffer_load_dwordx4 v38, s[28:31], s94 offen offset:2048 lds
    buffer_load_dwordx4 v39, s[28:31], s94 offen offset:3072 lds
    s_add_u32 s94, s94, 32768
    s_add_u32 m0, s88, 16384
    s_waitcnt vmcnt(20)
    ds_read_b64_tr_b16 a[80:81], v6 offset:32768
    ds_read_b64_tr_b16 a[82:83], v6 offset:34816
    ds_read_b64_tr_b16 a[84:85], v7 offset:32768
    ds_read_b64_tr_b16 a[86:87], v7 offset:34816
    ds_read_b64_tr_b16 a[88:89], v8 offset:32768
    ds_read_b64_tr_b16 a[90:91], v8 offset:34816
    ds_read_b64_tr_b16 a[92:93], v9 offset:32768
    ds_read_b64_tr_b16 a[94:95], v9 offset:34816
    s_waitcnt lgkmcnt(8)
    buffer_load_dwordx4 v36, s[28:31], s94 offen offset:0 lds
    buffer_load_dwordx4 v37, s[28:31], s94 offen offset:1024 lds
    buffer_load_dwordx4 v38, s[28:31], s94 offen offset:2048 lds
    buffer_load_dwordx4 v39, s[28:31], s94 offen offset:3072 lds
    s_add_u32 s94, s94, 32768
    s_add_u32 m0, s88, 32768
    s_waitcnt vmcnt(20)
    ds_read_b64_tr_b16 a[96:97], v2 offset:49152
    ds_read_b64_tr_b16 a[98:99], v2 offset:51200
    ds_read_b64_tr_b16 a[100:101], v3 offset:49152
    ds_read_b64_tr_b16 a[102:103], v3 offset:51200
    ds_read_b64_tr_b16 a[104:105], v4 offset:49152
    ds_read_b64_tr_b16 a[106:107], v4 offset:51200
    ds_read_b64_tr_b16 a[108:109], v5 offset:49152
    ds_read_b64_tr_b16 a[110:111], v5 offset:51200
    s_waitcnt lgkmcnt(8)
    buffer_load_dwordx4 v36, s[28:31], s94 offen offset:0 lds
    buffer_load_dwordx4 v37, s[28:31], s94 offen offset:1024 lds
    buffer_load_dwordx4 v38, s[28:31], s94 offen offset:2048 lds
    buffer_load_dwordx4 v39, s[28:31], s94 offen offset:3072 lds
    s_add_u32 s94, s94, 32768
    s_add_u32 m0, s88, 147456
    s_waitcnt lgkmcnt(0)
    buffer_load_dwordx4 v36, s[28:31], s94 offen offset:0 lds
    buffer_load_dwordx4 v37, s[28:31], s94 offen offset:1024 lds
    buffer_load_dwordx4 v38, s[28:31], s94 offen offset:2048 lds
    buffer_load_dwordx4 v39, s[28:31], s94 offen offset:3072 lds
    s_add_u32 s94, s94, 32768
    buffer_load_dword v28, v54, s[40:43], 0 offen sc1
    s_waitcnt vmcnt(0)
    v_cmp_ne_u32 vcc, v28, v53
    s_cbranch_vccnz L_rdy2_retry
L_rdy2_ok:
    buffer_load_dword v29, v51, s[32:35], 0 offen offset:0 sc1
    s_waitcnt vmcnt(0)
    v_cmp_ne_u32 vcc, v29, v52
    s_cbranch_vccnz L_pa2_retry
L_pa2_ok:
    s_mov_b32 s52, 1
    s_mov_b32 s53, 1
    s_mov_b32 s54, 1
    s_mov_b32 s55, 1
    s_mov_b32 s56, 1
    s_mov_b32 s57, 1
    s_mov_b32 s58, 1
    s_mov_b32 s59, 1
    s_mov_b32 s60, 1
    s_mov_b32 s61, 1
    s_mov_b32 s62, 1
    s_mov_b32 s63, 1
    s_mov_b32 s64, 1
    s_mov_b32 s65, 1
    s_waitcnt vmcnt(0) lgkmcnt(0)
    s_branch L_join
L_rdy_retry:
    s_mov_b32 s69, 0
L_rdy_loop:
    s_sleep 4
    buffer_load_dword v28, v54, s[40:43], 0 offen sc1
    s_add_u32 s69, s69, 1
    s_cmp_gt_u32 s69, 0x40000
    s_cbranch_scc1 L_rdy_ok
    s_waitcnt vmcnt(0)
    v_cmp_ne_u32 vcc, v28, v53
    s_cbranch_vccnz L_rdy_loop
    s_branch L_rdy_ok
L_pa_retry:
    s_mov_b32 s69, 0
L_pa_loop:
    s_sleep 4
    buffer_load_dword v29, v51, s[32:35], 0 offen offset:0 sc1
    s_add_u32 s69, s69, 1
    s_cmp_gt_u32 s69, 0x40000
    s_cbranch_scc1 L_pa_ok
    s_waitcnt vmcnt(0)
    v_cmp_ne_u32 vcc, v29, v52
    s_cbranch_vccnz L_pa_loop
    s_branch L_pa_ok
L_pb_retry:
    s_mov_b32 s69, 0
L_pb_loop:
    s_sleep 4
    buffer_load_dword v30, v51, s[32:35], 0 offen offset:512 sc1
    s_add_u32 s69, s69, 1
    s_cmp_gt_u32 s69, 0x40000
    s_cbranch_scc1 L_pb_ok
    s_waitcnt vmcnt(0)
    v_cmp_ne_u32 vcc, v30, v52
    s_cbranch_vccnz L_pb_loop
    s_branch L_pb_ok
L_rdy2_retry:
    s_mov_b32 s69, 0
L_rdy2_loop:
    s_sleep 4
    buffer_load_dword v28, v54, s[40:43], 0 offen sc1
    s_add_u32 s69, s69, 1
    s_cmp_gt_u32 s69, 0x40000
    s_cbranch_scc1 L_rdy2_ok
    s_waitcnt vmcnt(0)
    v_cmp_ne_u32 vcc, v28, v53
    s_cbranch_vccnz L_rdy2_loop
    s_branch L_rdy2_ok
L_pa2_retry:
    s_mov_b32 s69, 0
L_pa2_loop:
    s_sleep 16
    buffer_load_dword v29, v51, s[32:35], 0 offen offset:0 sc1
    s_add_u32 s69, s69, 1
    s_cmp_gt_u32 s69, 0x40000
    s_cbranch_scc1 L_pa2_ok
    s_waitcnt vmcnt(0)
    v_cmp_ne_u32 vcc, v29, v52
    s_cbranch_vccnz L_pa2_loop
    s_branch L_pa2_ok
.section .rodata,"a"
.p2align 6
.amdhsa_kernel standalone__dense_activation_squared_relu__prompt_kernel
  .amdhsa_next_free_vgpr 512
  .amdhsa_next_free_sgpr 102
  .amdhsa_accum_offset 256
  .amdhsa_group_segment_fixed_size 0
  .amdhsa_kernarg_size 64
  .amdhsa_user_sgpr_count 2
  .amdhsa_user_sgpr_kernarg_segment_ptr 1
  .amdhsa_system_sgpr_workgroup_id_x 1
  .amdhsa_float_denorm_mode_32 3
  .amdhsa_float_denorm_mode_16_64 3
.end_amdhsa_kernel
```
